```python
import torch

def _softmax(x, axis=-1):
    return torch.softmax(x, dim=axis)
def _gelu(x):
    return torch.nn.functional.gelu(x, approximate="tanh")
def _silu(x):
    return torch.nn.functional.silu(x)
def _sigmoid(x):
    return torch.sigmoid(x)
def _layernorm(x, axis=-1, eps=1e-5):
    m = x.mean(dim=axis, keepdim=True)
    v = x.var(dim=axis, keepdim=True, unbiased=False)
    return (x - m) / torch.sqrt(v + eps)
def _scatter_add(tgt, idx, src, axis=0):
    return tgt.clone().index_add_(axis, idx, src)
def _segment_sum(src, seg, n):
    out = torch.zeros((n,) + src.shape[1:], dtype=src.dtype)
    return out.index_add_(0, seg, src)
def _pad(x, pw):
    flat = tuple(v for pair in reversed(pw) for v in pair)
    return torch.nn.functional.pad(x, flat)

kernel_name = 'parallel_sum__ssm_conv_s4__dense_activation_gelu__prompt'

def setup_inputs():

    _w = (lambda a: (lambda t: t.to(torch.bfloat16) if t.is_floating_point() else t)(torch.as_tensor(a)))
    def _A_setup():
        B, L, D, N = 1, 2048, 448, 256
        A_re = -(lambda _x: torch.exp(torch.as_tensor(_x)))((lambda *s: torch.randn(*s, dtype=torch.bfloat16) * 6.4)(D, N))
        A_im = torch.pi * (lambda *s: torch.randn(*s, dtype=torch.bfloat16) * 0.05)(D, N)
        B_re = (lambda *s: torch.randn(*s, dtype=torch.bfloat16) * 0.1)(D, N)
        B_im = (lambda *s: torch.randn(*s, dtype=torch.bfloat16) * 0.1)(D, N)
        C_re = (lambda *s: torch.randn(*s, dtype=torch.bfloat16) * 0.1)(D, N)
        C_im = (lambda *s: torch.randn(*s, dtype=torch.bfloat16) * 0.1)(D, N)
        log_dt = (lambda *s: torch.randn(*s, dtype=torch.bfloat16) * 0.05)(D) * 0.5 - 4.0
        Dskip = (lambda *s: torch.randn(*s, dtype=torch.bfloat16) * 0.05)(D)
        return {
            "u": _w((lambda *s: torch.randn(*s, dtype=torch.bfloat16) * 0.05)(B, L, D)),
            "A_re": _w(A_re),
            "A_im": _w(A_im),
            "B_re": _w(B_re),
            "B_im": _w(B_im),
            "C_re": _w(C_re),
            "C_im": _w(C_im),
            "log_dt": _w(log_dt),
            "Dskip": _w(Dskip),
        }
    _A_in = _A_setup()

    def _B_setup():
        B, S, D, F = 1, 2048, 448, 1792
        return {
            "x": _w((lambda *s: torch.randn(*s, dtype=torch.bfloat16) * 0.05)(B, S, D)),
            "w1": _w((lambda *s: torch.randn(*s, dtype=torch.bfloat16) * 0.8)(D, F) * (D ** -0.5)),
            "b1": _w((lambda *s: torch.randn(*s, dtype=torch.bfloat16) * 0.2)(F) * 0.01),
            "w2": _w((lambda *s: torch.randn(*s, dtype=torch.bfloat16) * 0.2)(F, D) * (F ** -0.5)),
            "b2": _w((lambda *s: torch.randn(*s, dtype=torch.bfloat16) * 0.2)(D) * 0.01),
        }
    _B_in = _B_setup()

    return {
        "A_u": _A_in["u"],
        "A_A_re": _A_in["A_re"],
        "A_A_im": _A_in["A_im"],
        "A_B_re": _A_in["B_re"],
        "A_B_im": _A_in["B_im"],
        "A_C_re": _A_in["C_re"],
        "A_C_im": _A_in["C_im"],
        "A_log_dt": _A_in["log_dt"],
        "A_Dskip": _A_in["Dskip"],
        "B_x": _B_in["x"],
        "B_w1": _B_in["w1"],
        "B_b1": _B_in["b1"],
        "B_w2": _B_in["w2"],
        "B_b2": _B_in["b2"],
    }

def reference(A_u, A_A_re, A_A_im, A_B_re, A_B_im, A_C_re, A_C_im, A_log_dt, A_Dskip, B_x, B_w1, B_b1, B_w2, B_b2):
    def _A_ref(u, A_re, A_im, B_re, B_im, C_re, C_im, log_dt, Dskip):
        Bsz, L, D = u.shape
        dt = torch.exp(log_dt)[:, None]
        A = A_re + 1j * A_im
        Bc = B_re + 1j * B_im
        Cc = C_re + 1j * C_im
        logdA = dt * A
        dB = dt * Bc
        l = (lambda x, dt: x.to(dt))(torch.arange(L), A_re.dtype)
        P = torch.exp(logdA[:, :, None] * l[None, None, :])
        K = torch.einsum("dn,dnl,dn->dl", Cc, P, dB).real
        L2 = 2 * L
        Kp = _pad(K, ((0, 0), (0, L)))
        up = (lambda x, *d: x.permute(*d))(u, 0, 2, 1)
        up = _pad(up, ((0, 0), (0, 0), (0, L)))
        Kf = (lambda x, axes=(-2,-1): torch.fft.rfft2(x.float(), dim=axes))(Kp[:, None, :], axes=(-2, -1))
        Uf = (lambda x, axes=(-2,-1): torch.fft.rfft2(x.float(), dim=axes))(up[:, :, None, :], axes=(-2, -1))
        Yf = Uf * Kf[None, :, :, :]
        y = (lambda x, s, axes=(-2,-1): torch.fft.irfft2(x, s=s, dim=axes).to(torch.bfloat16))(Yf, (1, L2), axes=(-2, -1))[:, :, 0, :L]
        y = (lambda x, *d: x.permute(*d))(y, 0, 2, 1) + u * Dskip[None, None, :]
        return y

    def _B_ref(x, w1, b1, w2, b2):
        h = torch.einsum("bsd,df->bsf", x, w1) + b1
        h = _gelu(h)
        return torch.einsum("bsf,fd->bsd", h, w2) + b2

    x = A_u
    xn = _layernorm(x, axis=-1)
    return x + _A_ref(xn, A_A_re, A_A_im, A_B_re, A_B_im, A_C_re, A_C_im, A_log_dt, A_Dskip) + _B_ref(xn, B_w1, B_b1, B_w2, B_b2)
```

```asm
; @launch grid=(512,1,1) block=(256,1,1) lds=81920
.amdgcn_target "amdgcn-amd-amdhsa--gfx950"
.text
.globl parallel_sum__ssm_conv_s4__dense_activation_gelu__prompt_kernel
.p2align 8
.type parallel_sum__ssm_conv_s4__dense_activation_gelu__prompt_kernel,@function
parallel_sum__ssm_conv_s4__dense_activation_gelu__prompt_kernel:
    s_load_dwordx16 s[64:79], s[0:1], 0
    s_load_dwordx16 s[80:95], s[0:1], 64
    s_load_dwordx2 s[62:63], s[0:1], 128
    s_cmp_ge_u32 s2, 512
    s_cbranch_scc1 L_exit
    s_sub_u32 s3, s2, 288
    s_cmp_ge_u32 s2, 288
    s_cbranch_scc1 L_m
    s_mov_b32 s3, s2
    s_cmp_lt_u32 s2, 32
    s_cbranch_scc1 L_a
    s_sub_u32 s3, s2, 224
    s_cmp_ge_u32 s2, 256
    s_cbranch_scc1 L_a
    s_sub_u32 s3, s2, 32
L_s:
    s_getpc_b64 s[4:5]
L_s_pc:
    v_lshlrev_b32 v1, 7, v0
    v_cmp_gt_u32 vcc, 64, v0
    s_nop 0
    s_and_saveexec_b64 s[6:7], vcc
    s_cbranch_execz L_s_pf
    v_min_u32 v1, L_s_end-L_s_pc-4, v1
    global_load_dword v2, v1, s[4:5]
    v_add_u32 v1, 0x2000, v1
    v_min_u32 v1, L_s_end-L_s_pc-4, v1
    global_load_dword v2, v1, s[4:5]
L_s_pf:
    s_mov_b64 exec, s[6:7]
L_s_nopf:
    v_lshrrev_b32 v4, 6, v0
    v_and_b32 v3, 63, v0
    v_readfirstlane_b32 s36, v4
    s_getpc_b64 s[42:43]
L_s_tb_140196970036336:
    s_add_u32 s42, s42, lag_table-L_s_tb_140196970036336
    s_addc_u32 s43, s43, 0
    v_lshlrev_b32 v5, 4, v0
    global_load_dwordx4 v[16:19], v5, s[42:43]
    global_load_dwordx2 v[20:21], v5, s[42:43] offset:16
    s_lshr_b32 s37, s36, 1
    s_and_b32 s38, s36, 1
    s_waitcnt lgkmcnt(0)
    s_mov_b64 s[8:9], s[66:67]
    s_mov_b64 s[12:13], s[68:69]
    s_mov_b64 s[16:17], s[70:71]
    s_mov_b64 s[20:21], s[72:73]
    s_mov_b64 s[24:25], s[74:75]
    s_mov_b64 s[28:29], s[76:77]
    s_mov_b64 s[32:33], s[62:63]
    s_mov_b64 s[44:45], s[78:79]
    s_mov_b64 s[46:47], s[94:95]
    s_mov_b64 s[48:49], s[88:89]
    s_mov_b32 s10, 229376
    s_mov_b32 s11, 0x20000
    s_mov_b32 s14, 229376
    s_mov_b32 s15, 0x20000
    s_mov_b32 s18, 229376
    s_mov_b32 s19, 0x20000
    s_mov_b32 s22, 229376
    s_mov_b32 s23, 0x20000
    s_mov_b32 s26, 229376
    s_mov_b32 s27, 0x20000
    s_mov_b32 s30, 229376
    s_mov_b32 s31, 0x20000
    s_mov_b32 s34, 12988416
    s_mov_b32 s35, 0x20000
    s_lshl_b32 s39, s3, 2
    s_load_dword s41, s[44:45], s39
    s_lshl_b32 s39, s3, 1
    s_add_u32 s39, s39, s37
    s_lshl_b32 s39, s39, 9
    s_lshl_b32 s40, s38, 8
    s_add_u32 s39, s39, s40
    v_lshlrev_b32 v5, 2, v3
    buffer_load_dword v10, v5, s[8:11], s39 offen
    buffer_load_dword v11, v5, s[12:15], s39 offen
    buffer_load_dword v12, v5, s[16:19], s39 offen
    buffer_load_dword v13, v5, s[20:23], s39 offen
    buffer_load_dword v14, v5, s[24:27], s39 offen
    buffer_load_dword v15, v5, s[28:31], s39 offen
    s_mov_b32 s50, 1605632
    s_mov_b32 s51, 0x20000
    v_mov_b32 v32, 192
    v_mov_b32 v35, 1
    s_lshl_b32 s39, s36, 14
    s_add_u32 s39, s39, 16384
    v_bfe_u32 v6, v3, 1, 1
    v_lshlrev_b32 v6, 2, v6
    v_and_b32 v7, 1, v3
    v_or_b32 v6, v6, v7
    v_bfe_u32 v7, v3, 2, 1
    v_lshl_or_b32 v6, v7, 1, v6
    v_lshlrev_b32 v7, 7, v3
    v_lshl_add_u32 v7, v6, 4, v7
    v_add_u32 v38, s39, v7
    v_xor_b32 v39, 16, v38
    v_xor_b32 v40, 32, v38
    v_xor_b32 v41, 48, v38
    v_xor_b32 v42, 64, v38
    v_xor_b32 v43, 80, v38
    v_xor_b32 v44, 96, v38
    v_xor_b32 v45, 112, v38
    v_lshrrev_b32 v5, 5, v3
    v_bfe_u32 v6, v3, 2, 2
    v_lshl_add_u32 v5, v5, 2, v6
    v_bfe_u32 v6, v5, 1, 1
    v_lshlrev_b32 v6, 2, v6
    v_and_b32 v7, 1, v5
    v_or_b32 v6, v6, v7
    v_bfe_u32 v7, v5, 2, 1
    v_lshl_or_b32 v6, v7, 1, v6
    v_bfe_u32 v7, v3, 4, 1
    v_lshlrev_b32 v7, 1, v7
    v_bfe_u32 v8, v3, 1, 1
    v_add_u32 v7, v7, v8
    v_xor_b32 v7, v7, v6
    v_lshlrev_b32 v8, 7, v5
    v_lshl_add_u32 v8, v7, 4, v8
    v_and_b32 v9, 1, v3
    v_lshl_add_u32 v8, v9, 3, v8
    v_add_u32 v46, s39, v8
    v_xor_b32 v47, 64, v46
    s_waitcnt lgkmcnt(0)
    s_lshl_b32 s39, s41, 16
    s_and_b32 s40, s41, 0xffff0000
    s_cmp_eq_u32 s37, 0
    s_cselect_b32 s39, s39, s40
    v_mov_b32 v4, s39
    v_mov_b32 v5, 0x3fb8aa3b
    v_mul_f32 v6, v4, v5
    v_fma_f32 v7, v4, v5, -v6
    v_fmac_f32 v7, 0x32a57060, v4
    v_exp_f32 v6, v6
    s_nop 0
    v_mul_f32 v8, 0x3f317218, v6
    v_fma_f32 v6, v8, v7, v6
    v_cvt_pk_bf16_f32 v6, v6, v6
    v_and_b32 v22, 0xffff0000, v6
    s_waitcnt vmcnt(0)
    v_lshlrev_b32 v4, 16, v10
    v_lshlrev_b32 v5, 16, v11
    v_lshlrev_b32 v146, 16, v12
    v_lshlrev_b32 v147, 16, v13
    v_lshlrev_b32 v144, 16, v14
    v_lshlrev_b32 v145, 16, v15
    v_mul_f32 v4, v22, v4
    v_mul_f32 v5, v22, v5
    v_mul_f32 v206, 0x3fb8aa3b, v4
    v_mul_f32 v207, 0x3e22f983, v5
    v_mul_f32 v146, v22, v146
    v_mul_f32 v147, v22, v147
    v_mov_b32 v174, v206
    v_mov_b32 v177, v207
    v_ldexp_f32 v175, v206, 3
    v_ldexp_f32 v178, v207, 3
    v_ldexp_f32 v176, v206, 8
    v_ldexp_f32 v179, v207, 8
    v_fract_f32 v177, v177
    v_fract_f32 v178, v178
    v_fract_f32 v179, v179
    v_exp_f32 v174, v174
    v_exp_f32 v175, v175
    v_exp_f32 v176, v176
    v_cos_f32 v128, v177
    v_cos_f32 v134, v178
    v_cos_f32 v140, v179
    v_sin_f32 v129, v177
    v_sin_f32 v135, v178
    v_sin_f32 v141, v179
    v_mul_f32 v128, v174, v128
    v_mul_f32 v129, v174, v129
    v_mul_f32 v134, v175, v134
    v_mul_f32 v135, v175, v135
    v_mul_f32 v140, v176, v140
    v_mul_f32 v141, v176, v141
    v_mov_b32 v204, v147
    v_mov_b32 v205, v146
    v_mov_b32 v190, v129
    v_mov_b32 v191, v128
    v_mov_b32 v196, v135
    v_mov_b32 v197, v134
    v_pk_mul_f32 v[174:175], v[144:145], v[146:147] op_sel:[0,0] op_sel_hi:[0,1]
    v_pk_mul_f32 v[176:177], v[128:129], v[128:129] op_sel:[0,0] op_sel_hi:[0,1]
    v_pk_mul_f32 v[178:179], v[134:135], v[134:135] op_sel:[0,0] op_sel_hi:[0,1]
    v_pk_fma_f32 v[142:143], v[144:145], v[204:205], v[174:175] op_sel:[1,0,0] op_sel_hi:[1,1,1] neg_lo:[1,0,0]
    v_pk_fma_f32 v[130:131], v[128:129], v[190:191], v[176:177] op_sel:[1,0,0] op_sel_hi:[1,1,1] neg_lo:[1,0,0]
    v_pk_fma_f32 v[136:137], v[134:135], v[196:197], v[178:179] op_sel:[1,0,0] op_sel_hi:[1,1,1] neg_lo:[1,0,0]
    v_mov_b32 v202, v141
    v_mov_b32 v203, v140
    v_mov_b32 v192, v131
    v_mov_b32 v193, v130
    v_mov_b32 v198, v137
    v_mov_b32 v199, v136
    v_pk_mul_f32 v[174:175], v[142:143], v[128:129] op_sel:[0,0] op_sel_hi:[0,1]
    v_pk_mul_f32 v[176:177], v[142:143], v[140:141] op_sel:[0,0] op_sel_hi:[0,1]
    v_pk_mul_f32 v[178:179], v[130:131], v[130:131] op_sel:[0,0] op_sel_hi:[0,1]
    v_pk_mul_f32 v[180:181], v[136:137], v[136:137] op_sel:[0,0] op_sel_hi:[0,1]
    v_pk_mul_f32 v[182:183], v[134:135], v[136:137] op_sel:[0,0] op_sel_hi:[0,1]
    v_pk_mul_f32 v[184:185], v[142:143], v[130:131] op_sel:[0,0] op_sel_hi:[0,1]
    v_pk_fma_f32 v[150:151], v[142:143], v[190:191], v[174:175] op_sel:[1,0,0] op_sel_hi:[1,1,1] neg_lo:[1,0,0]
    v_pk_fma_f32 v[152:153], v[142:143], v[202:203], v[176:177] op_sel:[1,0,0] op_sel_hi:[1,1,1] neg_lo:[1,0,0]
    v_pk_fma_f32 v[132:133], v[130:131], v[192:193], v[178:179] op_sel:[1,0,0] op_sel_hi:[1,1,1] neg_lo:[1,0,0]
    v_pk_fma_f32 v[138:139], v[136:137], v[198:199], v[180:181] op_sel:[1,0,0] op_sel_hi:[1,1,1] neg_lo:[1,0,0]
    v_pk_fma_f32 v[172:173], v[134:135], v[198:199], v[182:183] op_sel:[1,0,0] op_sel_hi:[1,1,1] neg_lo:[1,0,0]
    v_pk_fma_f32 v[148:149], v[142:143], v[192:193], v[184:185] op_sel:[1,0,0] op_sel_hi:[1,1,1] neg_lo:[1,0,0]
    v_cvt_pk_bf16_f32 v96, v142, v150
    v_cvt_pk_bf16_f32 v108, -v143, -v151
    v_cvt_pk_bf16_f32 v64, 1.0, v134
    v_cvt_pk_bf16_f32 v80, 0, v135
    v_cvt_pk_bf16_f32 v65, v136, v172
    v_cvt_pk_bf16_f32 v81, v137, v173
    v_mov_b32 v194, v133
    v_mov_b32 v195, v132
    v_mov_b32 v200, v139
    v_mov_b32 v201, v138
    v_pk_mul_f32 v[174:175], v[150:151], v[130:131] op_sel:[0,0] op_sel_hi:[0,1]
    v_pk_mul_f32 v[176:177], v[152:153], v[130:131] op_sel:[0,0] op_sel_hi:[0,1]
    v_pk_mul_f32 v[178:179], v[152:153], v[132:133] op_sel:[0,0] op_sel_hi:[0,1]
    v_pk_mul_f32 v[180:181], v[152:153], v[140:141] op_sel:[0,0] op_sel_hi:[0,1]
    v_pk_mul_f32 v[182:183], v[134:135], v[138:139] op_sel:[0,0] op_sel_hi:[0,1]
    v_pk_mul_f32 v[184:185], v[136:137], v[138:139] op_sel:[0,0] op_sel_hi:[0,1]
    v_pk_mul_f32 v[186:187], v[172:173], v[138:139] op_sel:[0,0] op_sel_hi:[0,1]
    v_pk_fma_f32 v[150:151], v[150:151], v[192:193], v[174:175] op_sel:[1,0,0] op_sel_hi:[1,1,1] neg_lo:[1,0,0]
    v_pk_fma_f32 v[154:155], v[152:153], v[192:193], v[176:177] op_sel:[1,0,0] op_sel_hi:[1,1,1] neg_lo:[1,0,0]
    v_pk_fma_f32 v[156:157], v[152:153], v[194:195], v[178:179] op_sel:[1,0,0] op_sel_hi:[1,1,1] neg_lo:[1,0,0]
    v_pk_fma_f32 v[160:161], v[152:153], v[202:203], v[180:181] op_sel:[1,0,0] op_sel_hi:[1,1,1] neg_lo:[1,0,0]
    v_pk_fma_f32 v[168:169], v[134:135], v[200:201], v[182:183] op_sel:[1,0,0] op_sel_hi:[1,1,1] neg_lo:[1,0,0]
    v_pk_fma_f32 v[170:171], v[136:137], v[200:201], v[184:185] op_sel:[1,0,0] op_sel_hi:[1,1,1] neg_lo:[1,0,0]
    v_pk_fma_f32 v[172:173], v[172:173], v[200:201], v[186:187] op_sel:[1,0,0] op_sel_hi:[1,1,1] neg_lo:[1,0,0]
    v_cvt_pk_bf16_f32 v97, v148, v150
    v_cvt_pk_bf16_f32 v109, -v149, -v151
    v_cvt_pk_bf16_f32 v100, v152, v154
    v_cvt_pk_bf16_f32 v112, -v153, -v155
    v_cvt_pk_bf16_f32 v66, v138, v168
    v_cvt_pk_bf16_f32 v82, v139, v169
    v_cvt_pk_bf16_f32 v67, v170, v172
    v_cvt_pk_bf16_f32 v83, v171, v173
    v_pk_mul_f32 v[174:175], v[148:149], v[130:131] op_sel:[0,0] op_sel_hi:[0,1]
    v_pk_mul_f32 v[176:177], v[150:151], v[130:131] op_sel:[0,0] op_sel_hi:[0,1]
    v_pk_mul_f32 v[178:179], v[154:155], v[132:133] op_sel:[0,0] op_sel_hi:[0,1]
    v_pk_mul_f32 v[180:181], v[160:161], v[132:133] op_sel:[0,0] op_sel_hi:[0,1]
    v_pk_mul_f32 v[182:183], v[160:161], v[140:141] op_sel:[0,0] op_sel_hi:[0,1]
    v_pk_mul_f32 v[184:185], v[138:139], v[138:139] op_sel:[0,0] op_sel_hi:[0,1]
    v_pk_mul_f32 v[186:187], v[168:169], v[138:139] op_sel:[0,0] op_sel_hi:[0,1]
    v_pk_mul_f32 v[188:189], v[170:171], v[138:139] op_sel:[0,0] op_sel_hi:[0,1]
    v_pk_fma_f32 v[148:149], v[148:149], v[192:193], v[174:175] op_sel:[1,0,0] op_sel_hi:[1,1,1] neg_lo:[1,0,0]
    v_pk_fma_f32 v[150:151], v[150:151], v[192:193], v[176:177] op_sel:[1,0,0] op_sel_hi:[1,1,1] neg_lo:[1,0,0]
    v_pk_fma_f32 v[158:159], v[154:155], v[194:195], v[178:179] op_sel:[1,0,0] op_sel_hi:[1,1,1] neg_lo:[1,0,0]
    v_pk_fma_f32 v[162:163], v[160:161], v[194:195], v[180:181] op_sel:[1,0,0] op_sel_hi:[1,1,1] neg_lo:[1,0,0]
    v_pk_fma_f32 v[164:165], v[160:161], v[202:203], v[182:183] op_sel:[1,0,0] op_sel_hi:[1,1,1] neg_lo:[1,0,0]
    v_pk_fma_f32 v[166:167], v[138:139], v[200:201], v[184:185] op_sel:[1,0,0] op_sel_hi:[1,1,1] neg_lo:[1,0,0]
    v_pk_fma_f32 v[168:169], v[168:169], v[200:201], v[186:187] op_sel:[1,0,0] op_sel_hi:[1,1,1] neg_lo:[1,0,0]
    v_pk_fma_f32 v[170:171], v[170:171], v[200:201], v[188:189] op_sel:[1,0,0] op_sel_hi:[1,1,1] neg_lo:[1,0,0]
    v_cvt_pk_bf16_f32 v98, v148, v150
    v_cvt_pk_bf16_f32 v110, -v149, -v151
    v_cvt_pk_bf16_f32 v101, v156, v158
    v_cvt_pk_bf16_f32 v113, -v157, -v159
    v_cvt_pk_bf16_f32 v102, v160, v162
    v_cvt_pk_bf16_f32 v114, -v161, -v163
    v_pk_mul_f32 v[174:175], v[172:173], v[138:139] op_sel:[0,0] op_sel_hi:[0,1]
    v_pk_mul_f32 v[176:177], v[148:149], v[130:131] op_sel:[0,0] op_sel_hi:[0,1]
    v_pk_mul_f32 v[178:179], v[150:151], v[130:131] op_sel:[0,0] op_sel_hi:[0,1]
    v_pk_mul_f32 v[180:181], v[164:165], v[132:133] op_sel:[0,0] op_sel_hi:[0,1]
    v_pk_mul_f32 v[182:183], v[164:165], v[140:141] op_sel:[0,0] op_sel_hi:[0,1]
    v_pk_fma_f32 v[172:173], v[172:173], v[200:201], v[174:175] op_sel:[1,0,0] op_sel_hi:[1,1,1] neg_lo:[1,0,0]
    v_pk_fma_f32 v[148:149], v[148:149], v[192:193], v[176:177] op_sel:[1,0,0] op_sel_hi:[1,1,1] neg_lo:[1,0,0]
    v_pk_fma_f32 v[150:151], v[150:151], v[192:193], v[178:179] op_sel:[1,0,0] op_sel_hi:[1,1,1] neg_lo:[1,0,0]
    v_pk_fma_f32 v[162:163], v[164:165], v[194:195], v[180:181] op_sel:[1,0,0] op_sel_hi:[1,1,1] neg_lo:[1,0,0]
    v_pk_fma_f32 v[160:161], v[164:165], v[202:203], v[182:183] op_sel:[1,0,0] op_sel_hi:[1,1,1] neg_lo:[1,0,0]
    v_cvt_pk_bf16_f32 v68, v166, v168
    v_cvt_pk_bf16_f32 v84, v167, v169
    v_cvt_pk_bf16_f32 v69, v170, v172
    v_cvt_pk_bf16_f32 v85, v171, v173
    v_cvt_pk_bf16_f32 v99, v148, v150
    v_cvt_pk_bf16_f32 v111, -v149, -v151
    v_cvt_pk_bf16_f32 v103, v164, v162
    v_cvt_pk_bf16_f32 v115, -v165, -v163
    v_pk_mul_f32 v[174:175], v[166:167], v[138:139] op_sel:[0,0] op_sel_hi:[0,1]
    v_pk_mul_f32 v[176:177], v[168:169], v[138:139] op_sel:[0,0] op_sel_hi:[0,1]
    v_pk_mul_f32 v[178:179], v[170:171], v[138:139] op_sel:[0,0] op_sel_hi:[0,1]
    v_pk_mul_f32 v[180:181], v[172:173], v[138:139] op_sel:[0,0] op_sel_hi:[0,1]
    v_pk_mul_f32 v[182:183], v[160:161], v[140:141] op_sel:[0,0] op_sel_hi:[0,1]
    v_pk_fma_f32 v[166:167], v[166:167], v[200:201], v[174:175] op_sel:[1,0,0] op_sel_hi:[1,1,1] neg_lo:[1,0,0]
    v_pk_fma_f32 v[168:169], v[168:169], v[200:201], v[176:177] op_sel:[1,0,0] op_sel_hi:[1,1,1] neg_lo:[1,0,0]
    v_pk_fma_f32 v[170:171], v[170:171], v[200:201], v[178:179] op_sel:[1,0,0] op_sel_hi:[1,1,1] neg_lo:[1,0,0]
    v_pk_fma_f32 v[172:173], v[172:173], v[200:201], v[180:181] op_sel:[1,0,0] op_sel_hi:[1,1,1] neg_lo:[1,0,0]
    v_pk_fma_f32 v[162:163], v[160:161], v[202:203], v[182:183] op_sel:[1,0,0] op_sel_hi:[1,1,1] neg_lo:[1,0,0]
    v_cvt_pk_bf16_f32 v70, v166, v168
    v_cvt_pk_bf16_f32 v86, v167, v169
    v_cvt_pk_bf16_f32 v71, v170, v172
    v_cvt_pk_bf16_f32 v87, v171, v173
    v_cvt_pk_bf16_f32 v104, v160, v162
    v_cvt_pk_bf16_f32 v116, -v161, -v163
    v_pk_mul_f32 v[174:175], v[166:167], v[138:139] op_sel:[0,0] op_sel_hi:[0,1]
    v_pk_mul_f32 v[176:177], v[168:169], v[138:139] op_sel:[0,0] op_sel_hi:[0,1]
    v_pk_mul_f32 v[178:179], v[170:171], v[138:139] op_sel:[0,0] op_sel_hi:[0,1]
    v_pk_mul_f32 v[180:181], v[172:173], v[138:139] op_sel:[0,0] op_sel_hi:[0,1]
    v_pk_mul_f32 v[182:183], v[162:163], v[140:141] op_sel:[0,0] op_sel_hi:[0,1]
    v_pk_fma_f32 v[166:167], v[166:167], v[200:201], v[174:175] op_sel:[1,0,0] op_sel_hi:[1,1,1] neg_lo:[1,0,0]
    v_pk_fma_f32 v[168:169], v[168:169], v[200:201], v[176:177] op_sel:[1,0,0] op_sel_hi:[1,1,1] neg_lo:[1,0,0]
    v_pk_fma_f32 v[170:171], v[170:171], v[200:201], v[178:179] op_sel:[1,0,0] op_sel_hi:[1,1,1] neg_lo:[1,0,0]
    v_pk_fma_f32 v[172:173], v[172:173], v[200:201], v[180:181] op_sel:[1,0,0] op_sel_hi:[1,1,1] neg_lo:[1,0,0]
    v_pk_fma_f32 v[160:161], v[162:163], v[202:203], v[182:183] op_sel:[1,0,0] op_sel_hi:[1,1,1] neg_lo:[1,0,0]
    v_cvt_pk_bf16_f32 v72, v166, v168
    v_cvt_pk_bf16_f32 v88, v167, v169
    v_cvt_pk_bf16_f32 v73, v170, v172
    v_cvt_pk_bf16_f32 v89, v171, v173
    v_pk_mul_f32 v[174:175], v[166:167], v[138:139] op_sel:[0,0] op_sel_hi:[0,1]
    v_pk_mul_f32 v[176:177], v[168:169], v[138:139] op_sel:[0,0] op_sel_hi:[0,1]
    v_pk_mul_f32 v[178:179], v[170:171], v[138:139] op_sel:[0,0] op_sel_hi:[0,1]
    v_pk_mul_f32 v[180:181], v[172:173], v[138:139] op_sel:[0,0] op_sel_hi:[0,1]
    v_pk_mul_f32 v[182:183], v[160:161], v[140:141] op_sel:[0,0] op_sel_hi:[0,1]
    v_pk_fma_f32 v[166:167], v[166:167], v[200:201], v[174:175] op_sel:[1,0,0] op_sel_hi:[1,1,1] neg_lo:[1,0,0]
    v_pk_fma_f32 v[168:169], v[168:169], v[200:201], v[176:177] op_sel:[1,0,0] op_sel_hi:[1,1,1] neg_lo:[1,0,0]
    v_pk_fma_f32 v[170:171], v[170:171], v[200:201], v[178:179] op_sel:[1,0,0] op_sel_hi:[1,1,1] neg_lo:[1,0,0]
    v_pk_fma_f32 v[172:173], v[172:173], v[200:201], v[180:181] op_sel:[1,0,0] op_sel_hi:[1,1,1] neg_lo:[1,0,0]
    v_pk_fma_f32 v[162:163], v[160:161], v[202:203], v[182:183] op_sel:[1,0,0] op_sel_hi:[1,1,1] neg_lo:[1,0,0]
    v_cvt_pk_bf16_f32 v74, v166, v168
    v_cvt_pk_bf16_f32 v90, v167, v169
    v_cvt_pk_bf16_f32 v75, v170, v172
    v_cvt_pk_bf16_f32 v91, v171, v173
    v_cvt_pk_bf16_f32 v105, v160, v162
    v_cvt_pk_bf16_f32 v117, -v161, -v163
    v_pk_mul_f32 v[174:175], v[166:167], v[138:139] op_sel:[0,0] op_sel_hi:[0,1]
    v_pk_mul_f32 v[176:177], v[168:169], v[138:139] op_sel:[0,0] op_sel_hi:[0,1]
    v_pk_mul_f32 v[178:179], v[170:171], v[138:139] op_sel:[0,0] op_sel_hi:[0,1]
    v_pk_mul_f32 v[180:181], v[172:173], v[138:139] op_sel:[0,0] op_sel_hi:[0,1]
    v_pk_mul_f32 v[182:183], v[162:163], v[140:141] op_sel:[0,0] op_sel_hi:[0,1]
    v_pk_fma_f32 v[166:167], v[166:167], v[200:201], v[174:175] op_sel:[1,0,0] op_sel_hi:[1,1,1] neg_lo:[1,0,0]
    v_pk_fma_f32 v[168:169], v[168:169], v[200:201], v[176:177] op_sel:[1,0,0] op_sel_hi:[1,1,1] neg_lo:[1,0,0]
    v_pk_fma_f32 v[170:171], v[170:171], v[200:201], v[178:179] op_sel:[1,0,0] op_sel_hi:[1,1,1] neg_lo:[1,0,0]
    v_pk_fma_f32 v[172:173], v[172:173], v[200:201], v[180:181] op_sel:[1,0,0] op_sel_hi:[1,1,1] neg_lo:[1,0,0]
    v_pk_fma_f32 v[160:161], v[162:163], v[202:203], v[182:183] op_sel:[1,0,0] op_sel_hi:[1,1,1] neg_lo:[1,0,0]
    v_cvt_pk_bf16_f32 v76, v166, v168
    v_cvt_pk_bf16_f32 v92, v167, v169
    v_cvt_pk_bf16_f32 v77, v170, v172
    v_cvt_pk_bf16_f32 v93, v171, v173
    v_cvt_pk_bf16_f32 v106, v160, v160
    v_cvt_pk_bf16_f32 v118, -v161, -v161
    v_pk_mul_f32 v[174:175], v[166:167], v[138:139] op_sel:[0,0] op_sel_hi:[0,1]
    v_pk_mul_f32 v[176:177], v[168:169], v[138:139] op_sel:[0,0] op_sel_hi:[0,1]
    v_pk_mul_f32 v[178:179], v[170:171], v[138:139] op_sel:[0,0] op_sel_hi:[0,1]
    v_pk_mul_f32 v[180:181], v[172:173], v[138:139] op_sel:[0,0] op_sel_hi:[0,1]
    v_pk_fma_f32 v[166:167], v[166:167], v[200:201], v[174:175] op_sel:[1,0,0] op_sel_hi:[1,1,1] neg_lo:[1,0,0]
    v_pk_fma_f32 v[168:169], v[168:169], v[200:201], v[176:177] op_sel:[1,0,0] op_sel_hi:[1,1,1] neg_lo:[1,0,0]
    v_pk_fma_f32 v[170:171], v[170:171], v[200:201], v[178:179] op_sel:[1,0,0] op_sel_hi:[1,1,1] neg_lo:[1,0,0]
    v_pk_fma_f32 v[172:173], v[172:173], v[200:201], v[180:181] op_sel:[1,0,0] op_sel_hi:[1,1,1] neg_lo:[1,0,0]
    v_cvt_pk_bf16_f32 v78, v166, v168
    v_cvt_pk_bf16_f32 v94, v167, v169
    v_cvt_pk_bf16_f32 v79, v170, v172
    v_cvt_pk_bf16_f32 v95, v171, v173
    v_mov_b32 v107, 0
    v_mov_b32 v119, 0
    ds_write_b128 v38, v[64:67]
    ds_write_b128 v39, v[68:71]
    ds_write_b128 v40, v[72:75]
    ds_write_b128 v41, v[76:79]
    ds_write_b128 v42, v[80:83]
    ds_write_b128 v43, v[84:87]
    ds_write_b128 v44, v[88:91]
    ds_write_b128 v45, v[92:95]
    ds_write_b128 v38, v[96:99] offset:8192
    ds_write_b128 v42, v[108:111] offset:8192
    ds_write_b128 v39, v[100:103] offset:8192
    ds_write_b128 v43, v[112:115] offset:8192
    ds_write_b128 v40, v[104:107] offset:8192
    ds_write_b128 v44, v[116:119] offset:8192
    ds_read_b64_tr_b16 v[64:65], v46 offset:8192
    ds_read_b64_tr_b16 v[66:67], v47 offset:8192
    ds_read_b64_tr_b16 v[68:69], v46 offset:0
    ds_read_b64_tr_b16 v[70:71], v47 offset:0
    ds_read_b64_tr_b16 v[72:73], v46 offset:9216
    ds_read_b64_tr_b16 v[74:75], v47 offset:9216
    ds_read_b64_tr_b16 v[76:77], v46 offset:1024
    ds_read_b64_tr_b16 v[78:79], v47 offset:1024
    ds_read_b64_tr_b16 v[80:81], v46 offset:10240
    ds_read_b64_tr_b16 v[82:83], v47 offset:10240
    ds_read_b64_tr_b16 v[84:85], v46 offset:2048
    ds_read_b64_tr_b16 v[86:87], v47 offset:2048
    ds_read_b64_tr_b16 v[88:89], v46 offset:11264
    ds_read_b64_tr_b16 v[90:91], v47 offset:11264
    ds_read_b64_tr_b16 v[92:93], v46 offset:3072
    ds_read_b64_tr_b16 v[94:95], v47 offset:3072
    ds_read_b64_tr_b16 v[96:97], v46 offset:12288
    ds_read_b64_tr_b16 v[98:99], v47 offset:12288
    ds_read_b64_tr_b16 v[100:101], v46 offset:4096
    ds_read_b64_tr_b16 v[102:103], v47 offset:4096
    ds_read_b64_tr_b16 v[104:105], v46 offset:13312
    ds_read_b64_tr_b16 v[106:107], v47 offset:13312
    ds_read_b64_tr_b16 v[108:109], v46 offset:5120
    ds_read_b64_tr_b16 v[110:111], v47 offset:5120
    ds_read_b64_tr_b16 v[112:113], v46 offset:14336
    ds_read_b64_tr_b16 v[114:115], v47 offset:14336
    ds_read_b64_tr_b16 v[116:117], v46 offset:6144
    ds_read_b64_tr_b16 v[118:119], v47 offset:6144
    ds_read_b64_tr_b16 v[120:121], v46 offset:15360
    ds_read_b64_tr_b16 v[122:123], v47 offset:15360
    ds_read_b64_tr_b16 v[124:125], v46 offset:7168
    ds_read_b64_tr_b16 v[126:127], v47 offset:7168
    s_waitcnt lgkmcnt(15)
    v_mfma_f32_32x32x16_bf16 v[48:63], v[64:67], v[68:71], 0
    s_waitcnt lgkmcnt(15)
    v_mfma_f32_32x32x16_bf16 v[48:63], v[72:75], v[76:79], v[48:63]
    s_waitcnt lgkmcnt(15)
    v_mfma_f32_32x32x16_bf16 v[48:63], v[80:83], v[84:87], v[48:63]
    s_waitcnt lgkmcnt(15)
    v_mfma_f32_32x32x16_bf16 v[48:63], v[88:91], v[92:95], v[48:63]
    s_waitcnt lgkmcnt(12)
    v_mfma_f32_32x32x16_bf16 v[48:63], v[96:99], v[100:103], v[48:63]
    s_waitcnt lgkmcnt(8)
    v_mfma_f32_32x32x16_bf16 v[48:63], v[104:107], v[108:111], v[48:63]
    s_waitcnt lgkmcnt(4)
    v_mfma_f32_32x32x16_bf16 v[48:63], v[112:115], v[116:119], v[48:63]
    s_waitcnt lgkmcnt(0)
    v_mfma_f32_32x32x16_bf16 v[48:63], v[120:123], v[124:127], v[48:63]
    s_mov_b64 exec, 0x1
    global_load_dword v33, v32, s[46:47] sc1
    s_mov_b64 exec, -1
    v_and_b32 v4, 0xffff0000, v10
    v_and_b32 v5, 0xffff0000, v11
    v_and_b32 v146, 0xffff0000, v12
    v_and_b32 v147, 0xffff0000, v13
    v_and_b32 v144, 0xffff0000, v14
    v_and_b32 v145, 0xffff0000, v15
    v_mul_f32 v4, v22, v4
    v_mul_f32 v5, v22, v5
    v_mul_f32 v206, 0x3fb8aa3b, v4
    v_mul_f32 v207, 0x3e22f983, v5
    v_mul_f32 v146, v22, v146
    v_mul_f32 v147, v22, v147
    v_mov_b32 v174, v206
    v_mov_b32 v177, v207
    v_ldexp_f32 v175, v206, 3
    v_ldexp_f32 v178, v207, 3
    v_ldexp_f32 v176, v206, 8
    v_ldexp_f32 v179, v207, 8
    v_fract_f32 v177, v177
    v_fract_f32 v178, v178
    v_fract_f32 v179, v179
    v_exp_f32 v174, v174
    v_exp_f32 v175, v175
    v_exp_f32 v176, v176
    v_cos_f32 v128, v177
    v_cos_f32 v134, v178
    v_cos_f32 v140, v179
    v_sin_f32 v129, v177
    v_sin_f32 v135, v178
    v_sin_f32 v141, v179
    v_mul_f32 v128, v174, v128
    v_mul_f32 v129, v174, v129
    v_mul_f32 v134, v175, v134
    v_mul_f32 v135, v175, v135
    v_mul_f32 v140, v176, v140
    v_mul_f32 v141, v176, v141
    v_mov_b32 v204, v147
    v_mov_b32 v205, v146
    v_mov_b32 v190, v129
    v_mov_b32 v191, v128
    v_mov_b32 v196, v135
    v_mov_b32 v197, v134
    v_pk_mul_f32 v[174:175], v[144:145], v[146:147] op_sel:[0,0] op_sel_hi:[0,1]
    v_pk_mul_f32 v[176:177], v[128:129], v[128:129] op_sel:[0,0] op_sel_hi:[0,1]
    v_pk_mul_f32 v[178:179], v[134:135], v[134:135] op_sel:[0,0] op_sel_hi:[0,1]
    v_pk_fma_f32 v[142:143], v[144:145], v[204:205], v[174:175] op_sel:[1,0,0] op_sel_hi:[1,1,1] neg_lo:[1,0,0]
    v_pk_fma_f32 v[130:131], v[128:129], v[190:191], v[176:177] op_sel:[1,0,0] op_sel_hi:[1,1,1] neg_lo:[1,0,0]
    v_pk_fma_f32 v[136:137], v[134:135], v[196:197], v[178:179] op_sel:[1,0,0] op_sel_hi:[1,1,1] neg_lo:[1,0,0]
    v_mov_b32 v202, v141
    v_mov_b32 v203, v140
    v_mov_b32 v192, v131
    v_mov_b32 v193, v130
    v_mov_b32 v198, v137
    v_mov_b32 v199, v136
    v_pk_mul_f32 v[174:175], v[142:143], v[128:129] op_sel:[0,0] op_sel_hi:[0,1]
    v_pk_mul_f32 v[176:177], v[142:143], v[140:141] op_sel:[0,0] op_sel_hi:[0,1]
    v_pk_mul_f32 v[178:179], v[130:131], v[130:131] op_sel:[0,0] op_sel_hi:[0,1]
    v_pk_mul_f32 v[180:181], v[136:137], v[136:137] op_sel:[0,0] op_sel_hi:[0,1]
    v_pk_mul_f32 v[182:183], v[134:135], v[136:137] op_sel:[0,0] op_sel_hi:[0,1]
    v_pk_mul_f32 v[184:185], v[142:143], v[130:131] op_sel:[0,0] op_sel_hi:[0,1]
    v_pk_fma_f32 v[150:151], v[142:143], v[190:191], v[174:175] op_sel:[1,0,0] op_sel_hi:[1,1,1] neg_lo:[1,0,0]
    v_pk_fma_f32 v[152:153], v[142:143], v[202:203], v[176:177] op_sel:[1,0,0] op_sel_hi:[1,1,1] neg_lo:[1,0,0]
    v_pk_fma_f32 v[132:133], v[130:131], v[192:193], v[178:179] op_sel:[1,0,0] op_sel_hi:[1,1,1] neg_lo:[1,0,0]
    v_pk_fma_f32 v[138:139], v[136:137], v[198:199], v[180:181] op_sel:[1,0,0] op_sel_hi:[1,1,1] neg_lo:[1,0,0]
    v_pk_fma_f32 v[172:173], v[134:135], v[198:199], v[182:183] op_sel:[1,0,0] op_sel_hi:[1,1,1] neg_lo:[1,0,0]
    v_pk_fma_f32 v[148:149], v[142:143], v[192:193], v[184:185] op_sel:[1,0,0] op_sel_hi:[1,1,1] neg_lo:[1,0,0]
    v_cvt_pk_bf16_f32 v96, v142, v150
    v_cvt_pk_bf16_f32 v108, -v143, -v151
    v_cvt_pk_bf16_f32 v64, 1.0, v134
    v_cvt_pk_bf16_f32 v80, 0, v135
    v_cvt_pk_bf16_f32 v65, v136, v172
    v_cvt_pk_bf16_f32 v81, v137, v173
    v_mov_b32 v194, v133
    v_mov_b32 v195, v132
    v_mov_b32 v200, v139
    v_mov_b32 v201, v138
    v_pk_mul_f32 v[174:175], v[150:151], v[130:131] op_sel:[0,0] op_sel_hi:[0,1]
    v_pk_mul_f32 v[176:177], v[152:153], v[130:131] op_sel:[0,0] op_sel_hi:[0,1]
    v_pk_mul_f32 v[178:179], v[152:153], v[132:133] op_sel:[0,0] op_sel_hi:[0,1]
    v_pk_mul_f32 v[180:181], v[152:153], v[140:141] op_sel:[0,0] op_sel_hi:[0,1]
    v_pk_mul_f32 v[182:183], v[134:135], v[138:139] op_sel:[0,0] op_sel_hi:[0,1]
    v_pk_mul_f32 v[184:185], v[136:137], v[138:139] op_sel:[0,0] op_sel_hi:[0,1]
    v_pk_mul_f32 v[186:187], v[172:173], v[138:139] op_sel:[0,0] op_sel_hi:[0,1]
    v_pk_fma_f32 v[150:151], v[150:151], v[192:193], v[174:175] op_sel:[1,0,0] op_sel_hi:[1,1,1] neg_lo:[1,0,0]
    v_pk_fma_f32 v[154:155], v[152:153], v[192:193], v[176:177] op_sel:[1,0,0] op_sel_hi:[1,1,1] neg_lo:[1,0,0]
    v_pk_fma_f32 v[156:157], v[152:153], v[194:195], v[178:179] op_sel:[1,0,0] op_sel_hi:[1,1,1] neg_lo:[1,0,0]
    v_pk_fma_f32 v[160:161], v[152:153], v[202:203], v[180:181] op_sel:[1,0,0] op_sel_hi:[1,1,1] neg_lo:[1,0,0]
    v_pk_fma_f32 v[168:169], v[134:135], v[200:201], v[182:183] op_sel:[1,0,0] op_sel_hi:[1,1,1] neg_lo:[1,0,0]
    v_pk_fma_f32 v[170:171], v[136:137], v[200:201], v[184:185] op_sel:[1,0,0] op_sel_hi:[1,1,1] neg_lo:[1,0,0]
    v_pk_fma_f32 v[172:173], v[172:173], v[200:201], v[186:187] op_sel:[1,0,0] op_sel_hi:[1,1,1] neg_lo:[1,0,0]
    v_cvt_pk_bf16_f32 v97, v148, v150
    v_cvt_pk_bf16_f32 v109, -v149, -v151
    v_cvt_pk_bf16_f32 v100, v152, v154
    v_cvt_pk_bf16_f32 v112, -v153, -v155
    v_cvt_pk_bf16_f32 v66, v138, v168
    v_cvt_pk_bf16_f32 v82, v139, v169
    v_cvt_pk_bf16_f32 v67, v170, v172
    v_cvt_pk_bf16_f32 v83, v171, v173
    v_pk_mul_f32 v[174:175], v[148:149], v[130:131] op_sel:[0,0] op_sel_hi:[0,1]
    v_pk_mul_f32 v[176:177], v[150:151], v[130:131] op_sel:[0,0] op_sel_hi:[0,1]
    v_pk_mul_f32 v[178:179], v[154:155], v[132:133] op_sel:[0,0] op_sel_hi:[0,1]
    v_pk_mul_f32 v[180:181], v[160:161], v[132:133] op_sel:[0,0] op_sel_hi:[0,1]
    v_pk_mul_f32 v[182:183], v[160:161], v[140:141] op_sel:[0,0] op_sel_hi:[0,1]
    v_pk_mul_f32 v[184:185], v[138:139], v[138:139] op_sel:[0,0] op_sel_hi:[0,1]
    v_pk_mul_f32 v[186:187], v[168:169], v[138:139] op_sel:[0,0] op_sel_hi:[0,1]
    v_pk_mul_f32 v[188:189], v[170:171], v[138:139] op_sel:[0,0] op_sel_hi:[0,1]
    v_pk_fma_f32 v[148:149], v[148:149], v[192:193], v[174:175] op_sel:[1,0,0] op_sel_hi:[1,1,1] neg_lo:[1,0,0]
    v_pk_fma_f32 v[150:151], v[150:151], v[192:193], v[176:177] op_sel:[1,0,0] op_sel_hi:[1,1,1] neg_lo:[1,0,0]
    v_pk_fma_f32 v[158:159], v[154:155], v[194:195], v[178:179] op_sel:[1,0,0] op_sel_hi:[1,1,1] neg_lo:[1,0,0]
    v_pk_fma_f32 v[162:163], v[160:161], v[194:195], v[180:181] op_sel:[1,0,0] op_sel_hi:[1,1,1] neg_lo:[1,0,0]
    v_pk_fma_f32 v[164:165], v[160:161], v[202:203], v[182:183] op_sel:[1,0,0] op_sel_hi:[1,1,1] neg_lo:[1,0,0]
    v_pk_fma_f32 v[166:167], v[138:139], v[200:201], v[184:185] op_sel:[1,0,0] op_sel_hi:[1,1,1] neg_lo:[1,0,0]
    v_pk_fma_f32 v[168:169], v[168:169], v[200:201], v[186:187] op_sel:[1,0,0] op_sel_hi:[1,1,1] neg_lo:[1,0,0]
    v_pk_fma_f32 v[170:171], v[170:171], v[200:201], v[188:189] op_sel:[1,0,0] op_sel_hi:[1,1,1] neg_lo:[1,0,0]
    v_cvt_pk_bf16_f32 v98, v148, v150
    v_cvt_pk_bf16_f32 v110, -v149, -v151
    v_cvt_pk_bf16_f32 v101, v156, v158
    v_cvt_pk_bf16_f32 v113, -v157, -v159
    v_cvt_pk_bf16_f32 v102, v160, v162
    v_cvt_pk_bf16_f32 v114, -v161, -v163
    v_pk_mul_f32 v[174:175], v[172:173], v[138:139] op_sel:[0,0] op_sel_hi:[0,1]
    v_pk_mul_f32 v[176:177], v[148:149], v[130:131] op_sel:[0,0] op_sel_hi:[0,1]
    v_pk_mul_f32 v[178:179], v[150:151], v[130:131] op_sel:[0,0] op_sel_hi:[0,1]
    v_pk_mul_f32 v[180:181], v[164:165], v[132:133] op_sel:[0,0] op_sel_hi:[0,1]
    v_pk_mul_f32 v[182:183], v[164:165], v[140:141] op_sel:[0,0] op_sel_hi:[0,1]
    v_pk_fma_f32 v[172:173], v[172:173], v[200:201], v[174:175] op_sel:[1,0,0] op_sel_hi:[1,1,1] neg_lo:[1,0,0]
    v_pk_fma_f32 v[148:149], v[148:149], v[192:193], v[176:177] op_sel:[1,0,0] op_sel_hi:[1,1,1] neg_lo:[1,0,0]
    v_pk_fma_f32 v[150:151], v[150:151], v[192:193], v[178:179] op_sel:[1,0,0] op_sel_hi:[1,1,1] neg_lo:[1,0,0]
    v_pk_fma_f32 v[162:163], v[164:165], v[194:195], v[180:181] op_sel:[1,0,0] op_sel_hi:[1,1,1] neg_lo:[1,0,0]
    v_pk_fma_f32 v[160:161], v[164:165], v[202:203], v[182:183] op_sel:[1,0,0] op_sel_hi:[1,1,1] neg_lo:[1,0,0]
    v_cvt_pk_bf16_f32 v68, v166, v168
    v_cvt_pk_bf16_f32 v84, v167, v169
    v_cvt_pk_bf16_f32 v69, v170, v172
    v_cvt_pk_bf16_f32 v85, v171, v173
    v_cvt_pk_bf16_f32 v99, v148, v150
    v_cvt_pk_bf16_f32 v111, -v149, -v151
    v_cvt_pk_bf16_f32 v103, v164, v162
    v_cvt_pk_bf16_f32 v115, -v165, -v163
    v_pk_mul_f32 v[174:175], v[166:167], v[138:139] op_sel:[0,0] op_sel_hi:[0,1]
    v_pk_mul_f32 v[176:177], v[168:169], v[138:139] op_sel:[0,0] op_sel_hi:[0,1]
    v_pk_mul_f32 v[178:179], v[170:171], v[138:139] op_sel:[0,0] op_sel_hi:[0,1]
    v_pk_mul_f32 v[180:181], v[172:173], v[138:139] op_sel:[0,0] op_sel_hi:[0,1]
    v_pk_mul_f32 v[182:183], v[160:161], v[140:141] op_sel:[0,0] op_sel_hi:[0,1]
    v_pk_fma_f32 v[166:167], v[166:167], v[200:201], v[174:175] op_sel:[1,0,0] op_sel_hi:[1,1,1] neg_lo:[1,0,0]
    v_pk_fma_f32 v[168:169], v[168:169], v[200:201], v[176:177] op_sel:[1,0,0] op_sel_hi:[1,1,1] neg_lo:[1,0,0]
    v_pk_fma_f32 v[170:171], v[170:171], v[200:201], v[178:179] op_sel:[1,0,0] op_sel_hi:[1,1,1] neg_lo:[1,0,0]
    v_pk_fma_f32 v[172:173], v[172:173], v[200:201], v[180:181] op_sel:[1,0,0] op_sel_hi:[1,1,1] neg_lo:[1,0,0]
    v_pk_fma_f32 v[162:163], v[160:161], v[202:203], v[182:183] op_sel:[1,0,0] op_sel_hi:[1,1,1] neg_lo:[1,0,0]
    v_cvt_pk_bf16_f32 v70, v166, v168
    v_cvt_pk_bf16_f32 v86, v167, v169
    v_cvt_pk_bf16_f32 v71, v170, v172
    v_cvt_pk_bf16_f32 v87, v171, v173
    v_cvt_pk_bf16_f32 v104, v160, v162
    v_cvt_pk_bf16_f32 v116, -v161, -v163
    v_pk_mul_f32 v[174:175], v[166:167], v[138:139] op_sel:[0,0] op_sel_hi:[0,1]
    v_pk_mul_f32 v[176:177], v[168:169], v[138:139] op_sel:[0,0] op_sel_hi:[0,1]
    v_pk_mul_f32 v[178:179], v[170:171], v[138:139] op_sel:[0,0] op_sel_hi:[0,1]
    v_pk_mul_f32 v[180:181], v[172:173], v[138:139] op_sel:[0,0] op_sel_hi:[0,1]
    v_pk_mul_f32 v[182:183], v[162:163], v[140:141] op_sel:[0,0] op_sel_hi:[0,1]
    v_pk_fma_f32 v[166:167], v[166:167], v[200:201], v[174:175] op_sel:[1,0,0] op_sel_hi:[1,1,1] neg_lo:[1,0,0]
    v_pk_fma_f32 v[168:169], v[168:169], v[200:201], v[176:177] op_sel:[1,0,0] op_sel_hi:[1,1,1] neg_lo:[1,0,0]
    v_pk_fma_f32 v[170:171], v[170:171], v[200:201], v[178:179] op_sel:[1,0,0] op_sel_hi:[1,1,1] neg_lo:[1,0,0]
    v_pk_fma_f32 v[172:173], v[172:173], v[200:201], v[180:181] op_sel:[1,0,0] op_sel_hi:[1,1,1] neg_lo:[1,0,0]
    v_pk_fma_f32 v[160:161], v[162:163], v[202:203], v[182:183] op_sel:[1,0,0] op_sel_hi:[1,1,1] neg_lo:[1,0,0]
    v_cvt_pk_bf16_f32 v72, v166, v168
    v_cvt_pk_bf16_f32 v88, v167, v169
    v_cvt_pk_bf16_f32 v73, v170, v172
    v_cvt_pk_bf16_f32 v89, v171, v173
    v_pk_mul_f32 v[174:175], v[166:167], v[138:139] op_sel:[0,0] op_sel_hi:[0,1]
    v_pk_mul_f32 v[176:177], v[168:169], v[138:139] op_sel:[0,0] op_sel_hi:[0,1]
    v_pk_mul_f32 v[178:179], v[170:171], v[138:139] op_sel:[0,0] op_sel_hi:[0,1]
    v_pk_mul_f32 v[180:181], v[172:173], v[138:139] op_sel:[0,0] op_sel_hi:[0,1]
    v_pk_mul_f32 v[182:183], v[160:161], v[140:141] op_sel:[0,0] op_sel_hi:[0,1]
    v_pk_fma_f32 v[166:167], v[166:167], v[200:201], v[174:175] op_sel:[1,0,0] op_sel_hi:[1,1,1] neg_lo:[1,0,0]
    v_pk_fma_f32 v[168:169], v[168:169], v[200:201], v[176:177] op_sel:[1,0,0] op_sel_hi:[1,1,1] neg_lo:[1,0,0]
    v_pk_fma_f32 v[170:171], v[170:171], v[200:201], v[178:179] op_sel:[1,0,0] op_sel_hi:[1,1,1] neg_lo:[1,0,0]
    v_pk_fma_f32 v[172:173], v[172:173], v[200:201], v[180:181] op_sel:[1,0,0] op_sel_hi:[1,1,1] neg_lo:[1,0,0]
    v_pk_fma_f32 v[162:163], v[160:161], v[202:203], v[182:183] op_sel:[1,0,0] op_sel_hi:[1,1,1] neg_lo:[1,0,0]
    v_cvt_pk_bf16_f32 v74, v166, v168
    v_cvt_pk_bf16_f32 v90, v167, v169
    v_cvt_pk_bf16_f32 v75, v170, v172
    v_cvt_pk_bf16_f32 v91, v171, v173
    v_cvt_pk_bf16_f32 v105, v160, v162
    v_cvt_pk_bf16_f32 v117, -v161, -v163
    v_pk_mul_f32 v[174:175], v[166:167], v[138:139] op_sel:[0,0] op_sel_hi:[0,1]
    v_pk_mul_f32 v[176:177], v[168:169], v[138:139] op_sel:[0,0] op_sel_hi:[0,1]
    v_pk_mul_f32 v[178:179], v[170:171], v[138:139] op_sel:[0,0] op_sel_hi:[0,1]
    v_pk_mul_f32 v[180:181], v[172:173], v[138:139] op_sel:[0,0] op_sel_hi:[0,1]
    v_pk_mul_f32 v[182:183], v[162:163], v[140:141] op_sel:[0,0] op_sel_hi:[0,1]
    v_pk_fma_f32 v[166:167], v[166:167], v[200:201], v[174:175] op_sel:[1,0,0] op_sel_hi:[1,1,1] neg_lo:[1,0,0]
    v_pk_fma_f32 v[168:169], v[168:169], v[200:201], v[176:177] op_sel:[1,0,0] op_sel_hi:[1,1,1] neg_lo:[1,0,0]
    v_pk_fma_f32 v[170:171], v[170:171], v[200:201], v[178:179] op_sel:[1,0,0] op_sel_hi:[1,1,1] neg_lo:[1,0,0]
    v_pk_fma_f32 v[172:173], v[172:173], v[200:201], v[180:181] op_sel:[1,0,0] op_sel_hi:[1,1,1] neg_lo:[1,0,0]
    v_pk_fma_f32 v[160:161], v[162:163], v[202:203], v[182:183] op_sel:[1,0,0] op_sel_hi:[1,1,1] neg_lo:[1,0,0]
    v_cvt_pk_bf16_f32 v76, v166, v168
    v_cvt_pk_bf16_f32 v92, v167, v169
    v_cvt_pk_bf16_f32 v77, v170, v172
    v_cvt_pk_bf16_f32 v93, v171, v173
    v_cvt_pk_bf16_f32 v106, v160, v160
    v_cvt_pk_bf16_f32 v118, -v161, -v161
    v_pk_mul_f32 v[174:175], v[166:167], v[138:139] op_sel:[0,0] op_sel_hi:[0,1]
    v_pk_mul_f32 v[176:177], v[168:169], v[138:139] op_sel:[0,0] op_sel_hi:[0,1]
    v_pk_mul_f32 v[178:179], v[170:171], v[138:139] op_sel:[0,0] op_sel_hi:[0,1]
    v_pk_mul_f32 v[180:181], v[172:173], v[138:139] op_sel:[0,0] op_sel_hi:[0,1]
    v_pk_fma_f32 v[166:167], v[166:167], v[200:201], v[174:175] op_sel:[1,0,0] op_sel_hi:[1,1,1] neg_lo:[1,0,0]
    v_pk_fma_f32 v[168:169], v[168:169], v[200:201], v[176:177] op_sel:[1,0,0] op_sel_hi:[1,1,1] neg_lo:[1,0,0]
    v_pk_fma_f32 v[170:171], v[170:171], v[200:201], v[178:179] op_sel:[1,0,0] op_sel_hi:[1,1,1] neg_lo:[1,0,0]
    v_pk_fma_f32 v[172:173], v[172:173], v[200:201], v[180:181] op_sel:[1,0,0] op_sel_hi:[1,1,1] neg_lo:[1,0,0]
    v_cvt_pk_bf16_f32 v78, v166, v168
    v_cvt_pk_bf16_f32 v94, v167, v169
    v_cvt_pk_bf16_f32 v79, v170, v172
    v_cvt_pk_bf16_f32 v95, v171, v173
    v_mov_b32 v107, 0
    v_mov_b32 v119, 0
    ds_write_b128 v38, v[64:67]
    ds_write_b128 v39, v[68:71]
    ds_write_b128 v40, v[72:75]
    ds_write_b128 v41, v[76:79]
    ds_write_b128 v42, v[80:83]
    ds_write_b128 v43, v[84:87]
    ds_write_b128 v44, v[88:91]
    ds_write_b128 v45, v[92:95]
    ds_write_b128 v38, v[96:99] offset:8192
    ds_write_b128 v42, v[108:111] offset:8192
    ds_write_b128 v39, v[100:103] offset:8192
    ds_write_b128 v43, v[112:115] offset:8192
    ds_write_b128 v40, v[104:107] offset:8192
    ds_write_b128 v44, v[116:119] offset:8192
    ds_read_b64_tr_b16 v[64:65], v46 offset:8192
    ds_read_b64_tr_b16 v[66:67], v47 offset:8192
    ds_read_b64_tr_b16 v[68:69], v46 offset:0
    ds_read_b64_tr_b16 v[70:71], v47 offset:0
    ds_read_b64_tr_b16 v[72:73], v46 offset:9216
    ds_read_b64_tr_b16 v[74:75], v47 offset:9216
    ds_read_b64_tr_b16 v[76:77], v46 offset:1024
    ds_read_b64_tr_b16 v[78:79], v47 offset:1024
    ds_read_b64_tr_b16 v[80:81], v46 offset:10240
    ds_read_b64_tr_b16 v[82:83], v47 offset:10240
    ds_read_b64_tr_b16 v[84:85], v46 offset:2048
    ds_read_b64_tr_b16 v[86:87], v47 offset:2048
    ds_read_b64_tr_b16 v[88:89], v46 offset:11264
    ds_read_b64_tr_b16 v[90:91], v47 offset:11264
    ds_read_b64_tr_b16 v[92:93], v46 offset:3072
    ds_read_b64_tr_b16 v[94:95], v47 offset:3072
    ds_read_b64_tr_b16 v[96:97], v46 offset:12288
    ds_read_b64_tr_b16 v[98:99], v47 offset:12288
    ds_read_b64_tr_b16 v[100:101], v46 offset:4096
    ds_read_b64_tr_b16 v[102:103], v47 offset:4096
    ds_read_b64_tr_b16 v[104:105], v46 offset:13312
    ds_read_b64_tr_b16 v[106:107], v47 offset:13312
    ds_read_b64_tr_b16 v[108:109], v46 offset:5120
    ds_read_b64_tr_b16 v[110:111], v47 offset:5120
    ds_read_b64_tr_b16 v[112:113], v46 offset:14336
    ds_read_b64_tr_b16 v[114:115], v47 offset:14336
    ds_read_b64_tr_b16 v[116:117], v46 offset:6144
    ds_read_b64_tr_b16 v[118:119], v47 offset:6144
    ds_read_b64_tr_b16 v[120:121], v46 offset:15360
    ds_read_b64_tr_b16 v[122:123], v47 offset:15360
    ds_read_b64_tr_b16 v[124:125], v46 offset:7168
    ds_read_b64_tr_b16 v[126:127], v47 offset:7168
    s_waitcnt lgkmcnt(15)
    v_mfma_f32_32x32x16_bf16 v[48:63], v[64:67], v[68:71], v[48:63]
    s_waitcnt lgkmcnt(15)
    v_mfma_f32_32x32x16_bf16 v[48:63], v[72:75], v[76:79], v[48:63]
    s_waitcnt lgkmcnt(15)
    v_mfma_f32_32x32x16_bf16 v[48:63], v[80:83], v[84:87], v[48:63]
    s_waitcnt lgkmcnt(15)
    v_mfma_f32_32x32x16_bf16 v[48:63], v[88:91], v[92:95], v[48:63]
    s_waitcnt lgkmcnt(12)
    v_mfma_f32_32x32x16_bf16 v[48:63], v[96:99], v[100:103], v[48:63]
    s_waitcnt lgkmcnt(8)
    v_mfma_f32_32x32x16_bf16 v[48:63], v[104:107], v[108:111], v[48:63]
    s_waitcnt lgkmcnt(4)
    v_mfma_f32_32x32x16_bf16 v[48:63], v[112:115], v[116:119], v[48:63]
    s_waitcnt lgkmcnt(0)
    v_mfma_f32_32x32x16_bf16 v[48:63], v[120:123], v[124:127], v[48:63]
    s_mul_i32 s39, s37, 6160
    s_lshl_b32 s40, s38, 2
    s_add_u32 s39, s39, s40
    v_lshrrev_b32 v5, 5, v3
    v_lshlrev_b32 v5, 10, v5
    v_and_b32 v6, 31, v3
    v_lshl_add_u32 v5, v6, 3, v5
    v_add_u32 v5, s39, v5
    s_nop 3
    ds_write_b32 v5, v48 offset:0
    ds_write_b32 v5, v49 offset:256
    ds_write_b32 v5, v50 offset:512
    ds_write_b32 v5, v51 offset:768
    ds_write_b32 v5, v52 offset:2048
    ds_write_b32 v5, v53 offset:2304
    ds_write_b32 v5, v54 offset:2560
    ds_write_b32 v5, v55 offset:2816
    ds_write_b32 v5, v56 offset:4096
    ds_write_b32 v5, v57 offset:4352
    ds_write_b32 v5, v58 offset:4608
    ds_write_b32 v5, v59 offset:4864
    v_mov_b32 v6, 0
    v_mov_b32 v7, s39
    ds_write_b32 v7, v6 offset:6144
    s_waitcnt vmcnt(0)
    s_mov_b64 exec, 0x1
    v_cmp_le_u32 vcc, 1, v33
    s_nop 0
    s_cmp_eq_u64 vcc, exec
    s_mov_b64 exec, -1
    s_cbranch_scc1 L_xt_ok_1
    s_mov_b32 s88, 0x40000
L_spin_2:
    s_mov_b64 exec, 0x1
    global_load_dword v33, v32, s[46:47] sc1
    s_mov_b64 exec, -1
    s_waitcnt vmcnt(0)
    s_mov_b64 exec, 0x1
    v_cmp_le_u32 vcc, 1, v33
    s_nop 0
    s_cmp_eq_u64 vcc, exec
    s_mov_b64 exec, -1
    s_cbranch_scc1 L_spun_3
    s_sleep 8
    s_sub_u32 s88, s88, 1
    s_cmp_lg_u32 s88, 0
    s_cbranch_scc1 L_spin_2
L_spun_3:
L_xt_ok_1:
    v_lshrrev_b32 v5, 3, v0
    v_mul_u32_u24 v5, 28672, v5
    v_bfe_u32 v6, v0, 1, 2
    v_lshl_add_u32 v5, v6, 8, v5
    v_and_b32 v6, 1, v0
    v_lshl_add_u32 v5, v6, 4, v5
    s_lshr_b32 s39, s3, 3
    s_lshl_b32 s39, s39, 10
    s_and_b32 s40, s3, 7
    s_lshl_b32 s40, s40, 5
    s_add_u32 s39, s39, s40
    s_add_u32 s39, s39, 7340032
    buffer_load_dwordx4 v[24:27], v5, s[32:35], s39 offen sc1
    s_add_u32 s39, s39, 917504
    buffer_load_dwordx4 v[28:31], v5, s[32:35], s39 offen sc1
    v_and_b32 v48, 0xffff, v16
    v_lshrrev_b32 v49, 16, v16
    v_and_b32 v50, 0xffff, v17
    v_lshrrev_b32 v51, 16, v17
    v_and_b32 v52, 0xffff, v18
    v_lshrrev_b32 v53, 16, v18
    v_and_b32 v54, 0xffff, v19
    v_lshrrev_b32 v55, 16, v19
    v_and_b32 v56, 0xffff, v20
    v_lshrrev_b32 v57, 16, v20
    v_and_b32 v58, 0xffff, v21
    v_lshrrev_b32 v59, 16, v21
    s_waitcnt lgkmcnt(0)
    s_barrier
    v_lshlrev_b32 v100, 4, v0
    v_add_u32 v100, 12832, v100
    ds_read_b64 v[60:61], v48 offset:0
    ds_read_b64 v[62:63], v49 offset:0
    ds_read_b64 v[64:65], v50 offset:0
    ds_read_b64 v[66:67], v51 offset:0
    ds_read_b64 v[68:69], v52 offset:0
    ds_read_b64 v[70:71], v53 offset:0
    ds_read_b64 v[72:73], v54 offset:0
    ds_read_b64 v[74:75], v55 offset:0
    ds_read_b64 v[76:77], v56 offset:0
    ds_read_b64 v[78:79], v57 offset:0
    ds_read_b64 v[80:81], v58 offset:0
    ds_read_b64 v[82:83], v59 offset:0
    s_waitcnt lgkmcnt(8)
    v_add_f32 v60, v60, v61
    v_add_f32 v62, v62, v63
    v_add_f32 v64, v64, v65
    v_add_f32 v66, v66, v67
    s_waitcnt lgkmcnt(4)
    v_add_f32 v68, v68, v69
    v_add_f32 v70, v70, v71
    v_add_f32 v72, v72, v73
    v_add_f32 v74, v74, v75
    s_waitcnt lgkmcnt(0)
    v_add_f32 v76, v76, v77
    v_add_f32 v78, v78, v79
    v_add_f32 v80, v80, v81
    v_add_f32 v82, v82, v83
    v_cvt_pk_bf16_f32 v84, v60, v62
    v_cvt_pk_bf16_f32 v85, v64, v66
    v_cvt_pk_bf16_f32 v86, v68, v70
    v_cvt_pk_bf16_f32 v87, v72, v74
    v_cvt_pk_bf16_f32 v88, v76, v78
    v_cvt_pk_bf16_f32 v89, v80, v82
    v_alignbit_b32 v92, v85, v84, 16
    v_alignbit_b32 v93, v86, v85, 16
    v_alignbit_b32 v94, v87, v86, 16
    v_alignbit_b32 v95, v88, v87, 16
    v_alignbit_b32 v96, v89, v88, 16
    v_mov_b32 v104, v86
    v_mov_b32 v105, v87
    v_mov_b32 v106, v88
    v_mov_b32 v107, v89
    ds_write_b128 v100, v[104:107] offset:0
    v_mov_b32 v108, v85
    v_mov_b32 v109, v86
    v_mov_b32 v110, v87
    v_mov_b32 v111, v88
    ds_write_b128 v100, v[108:111] offset:8320
    v_mov_b32 v104, v93
    v_mov_b32 v105, v94
    v_mov_b32 v106, v95
    v_mov_b32 v107, v96
    ds_write_b128 v100, v[104:107] offset:4160
    ds_write_b128 v100, v[92:95] offset:12480
    ds_read_b64 v[60:61], v48 offset:6160
    ds_read_b64 v[62:63], v49 offset:6160
    ds_read_b64 v[64:65], v50 offset:6160
    ds_read_b64 v[66:67], v51 offset:6160
    ds_read_b64 v[68:69], v52 offset:6160
    ds_read_b64 v[70:71], v53 offset:6160
    ds_read_b64 v[72:73], v54 offset:6160
    ds_read_b64 v[74:75], v55 offset:6160
    ds_read_b64 v[76:77], v56 offset:6160
    ds_read_b64 v[78:79], v57 offset:6160
    ds_read_b64 v[80:81], v58 offset:6160
    ds_read_b64 v[82:83], v59 offset:6160
    s_waitcnt lgkmcnt(8)
    v_add_f32 v60, v60, v61
    v_add_f32 v62, v62, v63
    v_add_f32 v64, v64, v65
    v_add_f32 v66, v66, v67
    s_waitcnt lgkmcnt(4)
    v_add_f32 v68, v68, v69
    v_add_f32 v70, v70, v71
    v_add_f32 v72, v72, v73
    v_add_f32 v74, v74, v75
    s_waitcnt lgkmcnt(0)
    v_add_f32 v76, v76, v77
    v_add_f32 v78, v78, v79
    v_add_f32 v80, v80, v81
    v_add_f32 v82, v82, v83
    v_cvt_pk_bf16_f32 v84, v60, v62
    v_cvt_pk_bf16_f32 v85, v64, v66
    v_cvt_pk_bf16_f32 v86, v68, v70
    v_cvt_pk_bf16_f32 v87, v72, v74
    v_cvt_pk_bf16_f32 v88, v76, v78
    v_cvt_pk_bf16_f32 v89, v80, v82
    v_alignbit_b32 v92, v85, v84, 16
    v_alignbit_b32 v93, v86, v85, 16
    v_alignbit_b32 v94, v87, v86, 16
    v_alignbit_b32 v95, v88, v87, 16
    v_alignbit_b32 v96, v89, v88, 16
    v_mov_b32 v104, v86
    v_mov_b32 v105, v87
    v_mov_b32 v106, v88
    v_mov_b32 v107, v89
    ds_write_b128 v100, v[104:107] offset:16640
    v_mov_b32 v108, v85
    v_mov_b32 v109, v86
    v_mov_b32 v110, v87
    v_mov_b32 v111, v88
    ds_write_b128 v100, v[108:111] offset:24960
    v_mov_b32 v104, v93
    v_mov_b32 v105, v94
    v_mov_b32 v106, v95
    v_mov_b32 v107, v96
    ds_write_b128 v100, v[104:107] offset:20800
    ds_write_b128 v100, v[92:95] offset:29120
    v_mov_b32 v108, 0
    v_mov_b32 v109, 0
    v_mov_b32 v110, 0
    v_mov_b32 v111, 0
    v_and_b32 v5, 15, v3
    v_lshrrev_b32 v6, 1, v5
    v_mul_u32_u24 v6, 4160, v6
    v_and_b32 v5, 1, v5
    v_lshl_add_u32 v6, v5, 4, v6
    ds_write_b128 v6, v[108:111] offset:12800
    v_lshrrev_b32 v5, 5, v3
    v_mul_u32_u24 v5, 4608, v5
    v_and_b32 v6, 31, v3
    v_lshl_add_u32 v5, v6, 4, v5
    ds_write_b128 v5, v[108:111] offset:46080
    v_lshrrev_b32 v5, 3, v0
    v_lshlrev_b32 v5, 6, v5
    v_and_b32 v6, 1, v0
    v_mul_u32_u24 v6, 4608, v6
    v_add_u32 v5, v5, v6
    v_bfe_u32 v6, v0, 1, 2
    v_lshl_add_u32 v5, v6, 4, v5
    s_waitcnt vmcnt(0)
    ds_write_b128 v5, v[24:27] offset:46592
    ds_write_b128 v5, v[28:31] offset:48640
    s_mul_i32 s39, s37, 16640
    s_lshl_b32 s40, s38, 8
    s_add_u32 s39, s39, s40
    s_add_u32 s39, s39, 12856
    v_bfe_u32 v5, v3, 2, 2
    v_mul_u32_u24 v5, 4160, v5
    v_and_b32 v6, 3, v3
    v_lshl_add_u32 v5, v6, 3, v5
    v_lshrrev_b32 v6, 4, v3
    v_lshlrev_b32 v7, 4, v6
    v_sub_u32 v5, v5, v7
    v_add_u32 v156, s39, v5
    s_mul_i32 s39, s37, 4608
    s_lshl_b32 s40, s38, 8
    s_sub_u32 s39, s39, s40
    s_add_u32 s39, s39, 46368
    v_and_b32 v5, 15, v3
    v_lshlrev_b32 v5, 5, v5
    v_add_u32 v5, v5, v7
    v_add_u32 v157, s39, v5
    s_waitcnt lgkmcnt(0)
    s_barrier
    s_setprio 3
    ds_read_b128 v[80:83], v157 offset:192
    ds_read_b128 v[84:87], v157 offset:704
    ds_read_b128 v[88:91], v157 offset:1216
    ds_read_b128 v[92:95], v157 offset:1728
    ds_read_b128 v[96:99], v157 offset:2240
    ds_read_b128 v[100:103], v157 offset:2752
    ds_read_b128 v[104:107], v157 offset:3264
    ds_read_b128 v[108:111], v157 offset:3776
    ds_read_b64_tr_b16 v[144:145], v156 offset:8
    ds_read_b64_tr_b16 v[146:147], v156 offset:0
    ds_read_b64_tr_b16 v[148:149], v156 offset:520
    ds_read_b64_tr_b16 v[150:151], v156 offset:512
    s_waitcnt lgkmcnt(4)
    s_waitcnt lgkmcnt(2)
    v_mfma_f32_16x16x32_bf16 v[48:51], v[144:147], v[80:83], 0
    ds_read_b64_tr_b16 v[152:153], v156 offset:1032
    v_mfma_f32_16x16x32_bf16 v[52:55], v[144:147], v[84:87], 0
    ds_read_b64_tr_b16 v[154:155], v156 offset:1024
    v_mfma_f32_16x16x32_bf16 v[56:59], v[144:147], v[88:91], 0
    ds_read_b128 v[112:115], v157 offset:128
    v_mfma_f32_16x16x32_bf16 v[60:63], v[144:147], v[92:95], 0
    v_mfma_f32_16x16x32_bf16 v[64:67], v[144:147], v[96:99], 0
    v_mfma_f32_16x16x32_bf16 v[68:71], v[144:147], v[100:103], 0
    v_mfma_f32_16x16x32_bf16 v[72:75], v[144:147], v[104:107], 0
    v_mfma_f32_16x16x32_bf16 v[76:79], v[144:147], v[108:111], 0
    s_waitcnt lgkmcnt(3)
    v_mfma_f32_16x16x32_bf16 v[52:55], v[148:151], v[80:83], v[52:55]
    ds_read_b64_tr_b16 v[144:145], v156 offset:1544
    v_mfma_f32_16x16x32_bf16 v[56:59], v[148:151], v[84:87], v[56:59]
    ds_read_b64_tr_b16 v[146:147], v156 offset:1536
    v_mfma_f32_16x16x32_bf16 v[60:63], v[148:151], v[88:91], v[60:63]
    ds_read_b128 v[116:119], v157 offset:640
    v_mfma_f32_16x16x32_bf16 v[64:67], v[148:151], v[92:95], v[64:67]
    v_mfma_f32_16x16x32_bf16 v[68:71], v[148:151], v[96:99], v[68:71]
    v_mfma_f32_16x16x32_bf16 v[72:75], v[148:151], v[100:103], v[72:75]
    v_mfma_f32_16x16x32_bf16 v[76:79], v[148:151], v[104:107], v[76:79]
    s_waitcnt lgkmcnt(4)
    v_mfma_f32_16x16x32_bf16 v[56:59], v[152:155], v[80:83], v[56:59]
    ds_read_b64_tr_b16 v[148:149], v156 offset:2056
    v_mfma_f32_16x16x32_bf16 v[60:63], v[152:155], v[84:87], v[60:63]
    ds_read_b64_tr_b16 v[150:151], v156 offset:2048
    v_mfma_f32_16x16x32_bf16 v[64:67], v[152:155], v[88:91], v[64:67]
    ds_read_b128 v[120:123], v157 offset:1152
    v_mfma_f32_16x16x32_bf16 v[68:71], v[152:155], v[92:95], v[68:71]
    v_mfma_f32_16x16x32_bf16 v[72:75], v[152:155], v[96:99], v[72:75]
    v_mfma_f32_16x16x32_bf16 v[76:79], v[152:155], v[100:103], v[76:79]
    s_waitcnt lgkmcnt(4)
    v_mfma_f32_16x16x32_bf16 v[60:63], v[144:147], v[80:83], v[60:63]
    ds_read_b64_tr_b16 v[152:153], v156 offset:2568
    v_mfma_f32_16x16x32_bf16 v[64:67], v[144:147], v[84:87], v[64:67]
    ds_read_b64_tr_b16 v[154:155], v156 offset:2560
    v_mfma_f32_16x16x32_bf16 v[68:71], v[144:147], v[88:91], v[68:71]
    ds_read_b128 v[124:127], v157 offset:1664
    v_mfma_f32_16x16x32_bf16 v[72:75], v[144:147], v[92:95], v[72:75]
    v_mfma_f32_16x16x32_bf16 v[76:79], v[144:147], v[96:99], v[76:79]
    s_waitcnt lgkmcnt(4)
    v_mfma_f32_16x16x32_bf16 v[64:67], v[148:151], v[80:83], v[64:67]
    ds_read_b64_tr_b16 v[144:145], v156 offset:3080
    v_mfma_f32_16x16x32_bf16 v[68:71], v[148:151], v[84:87], v[68:71]
    ds_read_b64_tr_b16 v[146:147], v156 offset:3072
    v_mfma_f32_16x16x32_bf16 v[72:75], v[148:151], v[88:91], v[72:75]
    ds_read_b128 v[128:131], v157 offset:2176
    v_mfma_f32_16x16x32_bf16 v[76:79], v[148:151], v[92:95], v[76:79]
    s_waitcnt lgkmcnt(4)
    v_mfma_f32_16x16x32_bf16 v[68:71], v[152:155], v[80:83], v[68:71]
    ds_read_b64_tr_b16 v[148:149], v156 offset:3592
    v_mfma_f32_16x16x32_bf16 v[72:75], v[152:155], v[84:87], v[72:75]
    ds_read_b64_tr_b16 v[150:151], v156 offset:3584
    v_mfma_f32_16x16x32_bf16 v[76:79], v[152:155], v[88:91], v[76:79]
    ds_read_b128 v[132:135], v157 offset:2688
    s_waitcnt lgkmcnt(4)
    v_mfma_f32_16x16x32_bf16 v[72:75], v[144:147], v[80:83], v[72:75]
    ds_read_b64_tr_b16 v[152:153], v156 offset:72
    v_mfma_f32_16x16x32_bf16 v[76:79], v[144:147], v[84:87], v[76:79]
    ds_read_b64_tr_b16 v[154:155], v156 offset:64
    ds_read_b128 v[136:139], v157 offset:3200
    s_waitcnt lgkmcnt(4)
    v_mfma_f32_16x16x32_bf16 v[76:79], v[148:151], v[80:83], v[76:79]
    ds_read_b64_tr_b16 v[144:145], v156 offset:584
    ds_read_b64_tr_b16 v[146:147], v156 offset:576
    ds_read_b128 v[140:143], v157 offset:3712
    s_waitcnt lgkmcnt(0)
    v_mfma_f32_16x16x32_bf16 v[48:51], v[152:155], v[112:115], v[48:51]
    ds_read_b64_tr_b16 v[148:149], v156 offset:1096
    v_mfma_f32_16x16x32_bf16 v[52:55], v[152:155], v[116:119], v[52:55]
    ds_read_b64_tr_b16 v[150:151], v156 offset:1088
    v_mfma_f32_16x16x32_bf16 v[56:59], v[152:155], v[120:123], v[56:59]
    ds_read_b128 v[80:83], v157 offset:64
    v_mfma_f32_16x16x32_bf16 v[60:63], v[152:155], v[124:127], v[60:63]
    v_mfma_f32_16x16x32_bf16 v[64:67], v[152:155], v[128:131], v[64:67]
    v_mfma_f32_16x16x32_bf16 v[68:71], v[152:155], v[132:135], v[68:71]
    v_mfma_f32_16x16x32_bf16 v[72:75], v[152:155], v[136:139], v[72:75]
    v_mfma_f32_16x16x32_bf16 v[76:79], v[152:155], v[140:143], v[76:79]
    v_mfma_f32_16x16x32_bf16 v[52:55], v[144:147], v[112:115], v[52:55]
    ds_read_b64_tr_b16 v[152:153], v156 offset:1608
    v_mfma_f32_16x16x32_bf16 v[56:59], v[144:147], v[116:119], v[56:59]
    ds_read_b64_tr_b16 v[154:155], v156 offset:1600
    v_mfma_f32_16x16x32_bf16 v[60:63], v[144:147], v[120:123], v[60:63]
    ds_read_b128 v[84:87], v157 offset:576
    v_mfma_f32_16x16x32_bf16 v[64:67], v[144:147], v[124:127], v[64:67]
    v_mfma_f32_16x16x32_bf16 v[68:71], v[144:147], v[128:131], v[68:71]
    v_mfma_f32_16x16x32_bf16 v[72:75], v[144:147], v[132:135], v[72:75]
    v_mfma_f32_16x16x32_bf16 v[76:79], v[144:147], v[136:139], v[76:79]
    s_waitcnt lgkmcnt(4)
    v_mfma_f32_16x16x32_bf16 v[56:59], v[148:151], v[112:115], v[56:59]
    ds_read_b64_tr_b16 v[144:145], v156 offset:2120
    v_mfma_f32_16x16x32_bf16 v[60:63], v[148:151], v[116:119], v[60:63]
    ds_read_b64_tr_b16 v[146:147], v156 offset:2112
    v_mfma_f32_16x16x32_bf16 v[64:67], v[148:151], v[120:123], v[64:67]
    ds_read_b128 v[88:91], v157 offset:1088
    v_mfma_f32_16x16x32_bf16 v[68:71], v[148:151], v[124:127], v[68:71]
    v_mfma_f32_16x16x32_bf16 v[72:75], v[148:151], v[128:131], v[72:75]
    v_mfma_f32_16x16x32_bf16 v[76:79], v[148:151], v[132:135], v[76:79]
    s_waitcnt lgkmcnt(4)
    v_mfma_f32_16x16x32_bf16 v[60:63], v[152:155], v[112:115], v[60:63]
    ds_read_b64_tr_b16 v[148:149], v156 offset:2632
    v_mfma_f32_16x16x32_bf16 v[64:67], v[152:155], v[116:119], v[64:67]
    ds_read_b64_tr_b16 v[150:151], v156 offset:2624
    v_mfma_f32_16x16x32_bf16 v[68:71], v[152:155], v[120:123], v[68:71]
    ds_read_b128 v[92:95], v157 offset:1600
    v_mfma_f32_16x16x32_bf16 v[72:75], v[152:155], v[124:127], v[72:75]
    v_mfma_f32_16x16x32_bf16 v[76:79], v[152:155], v[128:131], v[76:79]
    s_waitcnt lgkmcnt(4)
    v_mfma_f32_16x16x32_bf16 v[64:67], v[144:147], v[112:115], v[64:67]
    ds_read_b64_tr_b16 v[152:153], v156 offset:3144
    v_mfma_f32_16x16x32_bf16 v[68:71], v[144:147], v[116:119], v[68:71]
    ds_read_b64_tr_b16 v[154:155], v156 offset:3136
    v_mfma_f32_16x16x32_bf16 v[72:75], v[144:147], v[120:123], v[72:75]
    ds_read_b128 v[96:99], v157 offset:2112
    v_mfma_f32_16x16x32_bf16 v[76:79], v[144:147], v[124:127], v[76:79]
    s_waitcnt lgkmcnt(4)
    v_mfma_f32_16x16x32_bf16 v[68:71], v[148:151], v[112:115], v[68:71]
    ds_read_b64_tr_b16 v[144:145], v156 offset:3656
    v_mfma_f32_16x16x32_bf16 v[72:75], v[148:151], v[116:119], v[72:75]
    ds_read_b64_tr_b16 v[146:147], v156 offset:3648
    v_mfma_f32_16x16x32_bf16 v[76:79], v[148:151], v[120:123], v[76:79]
    ds_read_b128 v[100:103], v157 offset:2624
    s_waitcnt lgkmcnt(4)
    v_mfma_f32_16x16x32_bf16 v[72:75], v[152:155], v[112:115], v[72:75]
    ds_read_b64_tr_b16 v[148:149], v156 offset:136
    v_mfma_f32_16x16x32_bf16 v[76:79], v[152:155], v[116:119], v[76:79]
    ds_read_b64_tr_b16 v[150:151], v156 offset:128
    ds_read_b128 v[104:107], v157 offset:3136
    s_waitcnt lgkmcnt(4)
    v_mfma_f32_16x16x32_bf16 v[76:79], v[144:147], v[112:115], v[76:79]
    ds_read_b64_tr_b16 v[152:153], v156 offset:648
    ds_read_b64_tr_b16 v[154:155], v156 offset:640
    ds_read_b128 v[108:111], v157 offset:3648
    s_waitcnt lgkmcnt(0)
    v_mfma_f32_16x16x32_bf16 v[48:51], v[148:151], v[80:83], v[48:51]
    ds_read_b64_tr_b16 v[144:145], v156 offset:1160
    v_mfma_f32_16x16x32_bf16 v[52:55], v[148:151], v[84:87], v[52:55]
    ds_read_b64_tr_b16 v[146:147], v156 offset:1152
    v_mfma_f32_16x16x32_bf16 v[56:59], v[148:151], v[88:91], v[56:59]
    ds_read_b128 v[112:115], v157 offset:0
    v_mfma_f32_16x16x32_bf16 v[60:63], v[148:151], v[92:95], v[60:63]
    v_mfma_f32_16x16x32_bf16 v[64:67], v[148:151], v[96:99], v[64:67]
    v_mfma_f32_16x16x32_bf16 v[68:71], v[148:151], v[100:103], v[68:71]
    v_mfma_f32_16x16x32_bf16 v[72:75], v[148:151], v[104:107], v[72:75]
    v_mfma_f32_16x16x32_bf16 v[76:79], v[148:151], v[108:111], v[76:79]
    v_mfma_f32_16x16x32_bf16 v[52:55], v[152:155], v[80:83], v[52:55]
    ds_read_b64_tr_b16 v[148:149], v156 offset:1672
    v_mfma_f32_16x16x32_bf16 v[56:59], v[152:155], v[84:87], v[56:59]
    ds_read_b64_tr_b16 v[150:151], v156 offset:1664
    v_mfma_f32_16x16x32_bf16 v[60:63], v[152:155], v[88:91], v[60:63]
    ds_read_b128 v[116:119], v157 offset:512
    v_mfma_f32_16x16x32_bf16 v[64:67], v[152:155], v[92:95], v[64:67]
    v_mfma_f32_16x16x32_bf16 v[68:71], v[152:155], v[96:99], v[68:71]
    v_mfma_f32_16x16x32_bf16 v[72:75], v[152:155], v[100:103], v[72:75]
    v_mfma_f32_16x16x32_bf16 v[76:79], v[152:155], v[104:107], v[76:79]
    s_waitcnt lgkmcnt(4)
    v_mfma_f32_16x16x32_bf16 v[56:59], v[144:147], v[80:83], v[56:59]
    ds_read_b64_tr_b16 v[152:153], v156 offset:2184
    v_mfma_f32_16x16x32_bf16 v[60:63], v[144:147], v[84:87], v[60:63]
    ds_read_b64_tr_b16 v[154:155], v156 offset:2176
    v_mfma_f32_16x16x32_bf16 v[64:67], v[144:147], v[88:91], v[64:67]
    ds_read_b128 v[120:123], v157 offset:1024
    v_mfma_f32_16x16x32_bf16 v[68:71], v[144:147], v[92:95], v[68:71]
    v_mfma_f32_16x16x32_bf16 v[72:75], v[144:147], v[96:99], v[72:75]
    v_mfma_f32_16x16x32_bf16 v[76:79], v[144:147], v[100:103], v[76:79]
    s_waitcnt lgkmcnt(4)
    v_mfma_f32_16x16x32_bf16 v[60:63], v[148:151], v[80:83], v[60:63]
    ds_read_b64_tr_b16 v[144:145], v156 offset:2696
    v_mfma_f32_16x16x32_bf16 v[64:67], v[148:151], v[84:87], v[64:67]
    ds_read_b64_tr_b16 v[146:147], v156 offset:2688
    v_mfma_f32_16x16x32_bf16 v[68:71], v[148:151], v[88:91], v[68:71]
    ds_read_b128 v[124:127], v157 offset:1536
    v_mfma_f32_16x16x32_bf16 v[72:75], v[148:151], v[92:95], v[72:75]
    v_mfma_f32_16x16x32_bf16 v[76:79], v[148:151], v[96:99], v[76:79]
    s_waitcnt lgkmcnt(4)
    v_mfma_f32_16x16x32_bf16 v[64:67], v[152:155], v[80:83], v[64:67]
    ds_read_b64_tr_b16 v[148:149], v156 offset:3208
    v_mfma_f32_16x16x32_bf16 v[68:71], v[152:155], v[84:87], v[68:71]
    ds_read_b64_tr_b16 v[150:151], v156 offset:3200
    v_mfma_f32_16x16x32_bf16 v[72:75], v[152:155], v[88:91], v[72:75]
    ds_read_b128 v[128:131], v157 offset:2048
    v_mfma_f32_16x16x32_bf16 v[76:79], v[152:155], v[92:95], v[76:79]
    s_waitcnt lgkmcnt(4)
    v_mfma_f32_16x16x32_bf16 v[68:71], v[144:147], v[80:83], v[68:71]
    ds_read_b64_tr_b16 v[152:153], v156 offset:3720
    v_mfma_f32_16x16x32_bf16 v[72:75], v[144:147], v[84:87], v[72:75]
    ds_read_b64_tr_b16 v[154:155], v156 offset:3712
    v_mfma_f32_16x16x32_bf16 v[76:79], v[144:147], v[88:91], v[76:79]
    ds_read_b128 v[132:135], v157 offset:2560
    s_waitcnt lgkmcnt(4)
    v_mfma_f32_16x16x32_bf16 v[72:75], v[148:151], v[80:83], v[72:75]
    ds_read_b64_tr_b16 v[144:145], v156 offset:200
    v_mfma_f32_16x16x32_bf16 v[76:79], v[148:151], v[84:87], v[76:79]
    ds_read_b64_tr_b16 v[146:147], v156 offset:192
    ds_read_b128 v[136:139], v157 offset:3072
    s_waitcnt lgkmcnt(4)
    v_mfma_f32_16x16x32_bf16 v[76:79], v[152:155], v[80:83], v[76:79]
    ds_read_b64_tr_b16 v[148:149], v156 offset:712
    ds_read_b64_tr_b16 v[150:151], v156 offset:704
    ds_read_b128 v[140:143], v157 offset:3584
    s_waitcnt lgkmcnt(0)
    v_mfma_f32_16x16x32_bf16 v[48:51], v[144:147], v[112:115], v[48:51]
    ds_read_b64_tr_b16 v[152:153], v156 offset:1224
    v_mfma_f32_16x16x32_bf16 v[52:55], v[144:147], v[116:119], v[52:55]
    ds_read_b64_tr_b16 v[154:155], v156 offset:1216
    v_mfma_f32_16x16x32_bf16 v[56:59], v[144:147], v[120:123], v[56:59]
    v_mfma_f32_16x16x32_bf16 v[60:63], v[144:147], v[124:127], v[60:63]
    v_mfma_f32_16x16x32_bf16 v[64:67], v[144:147], v[128:131], v[64:67]
    v_mfma_f32_16x16x32_bf16 v[68:71], v[144:147], v[132:135], v[68:71]
    v_mfma_f32_16x16x32_bf16 v[72:75], v[144:147], v[136:139], v[72:75]
    v_mfma_f32_16x16x32_bf16 v[76:79], v[144:147], v[140:143], v[76:79]
    v_mfma_f32_16x16x32_bf16 v[52:55], v[148:151], v[112:115], v[52:55]
    ds_read_b64_tr_b16 v[144:145], v156 offset:1736
    v_mfma_f32_16x16x32_bf16 v[56:59], v[148:151], v[116:119], v[56:59]
    ds_read_b64_tr_b16 v[146:147], v156 offset:1728
    v_mfma_f32_16x16x32_bf16 v[60:63], v[148:151], v[120:123], v[60:63]
    v_mfma_f32_16x16x32_bf16 v[64:67], v[148:151], v[124:127], v[64:67]
    v_mfma_f32_16x16x32_bf16 v[68:71], v[148:151], v[128:131], v[68:71]
    v_mfma_f32_16x16x32_bf16 v[72:75], v[148:151], v[132:135], v[72:75]
    v_mfma_f32_16x16x32_bf16 v[76:79], v[148:151], v[136:139], v[76:79]
    s_waitcnt lgkmcnt(2)
    v_mfma_f32_16x16x32_bf16 v[56:59], v[152:155], v[112:115], v[56:59]
    ds_read_b64_tr_b16 v[148:149], v156 offset:2248
    v_mfma_f32_16x16x32_bf16 v[60:63], v[152:155], v[116:119], v[60:63]
    ds_read_b64_tr_b16 v[150:151], v156 offset:2240
    v_mfma_f32_16x16x32_bf16 v[64:67], v[152:155], v[120:123], v[64:67]
    v_mfma_f32_16x16x32_bf16 v[68:71], v[152:155], v[124:127], v[68:71]
    v_mfma_f32_16x16x32_bf16 v[72:75], v[152:155], v[128:131], v[72:75]
    v_mfma_f32_16x16x32_bf16 v[76:79], v[152:155], v[132:135], v[76:79]
    s_waitcnt lgkmcnt(2)
    v_mfma_f32_16x16x32_bf16 v[60:63], v[144:147], v[112:115], v[60:63]
    ds_read_b64_tr_b16 v[152:153], v156 offset:2760
    v_mfma_f32_16x16x32_bf16 v[64:67], v[144:147], v[116:119], v[64:67]
    ds_read_b64_tr_b16 v[154:155], v156 offset:2752
    v_mfma_f32_16x16x32_bf16 v[68:71], v[144:147], v[120:123], v[68:71]
    v_mfma_f32_16x16x32_bf16 v[72:75], v[144:147], v[124:127], v[72:75]
    v_mfma_f32_16x16x32_bf16 v[76:79], v[144:147], v[128:131], v[76:79]
    s_waitcnt lgkmcnt(2)
    v_mfma_f32_16x16x32_bf16 v[64:67], v[148:151], v[112:115], v[64:67]
    ds_read_b64_tr_b16 v[144:145], v156 offset:3272
    v_mfma_f32_16x16x32_bf16 v[68:71], v[148:151], v[116:119], v[68:71]
    ds_read_b64_tr_b16 v[146:147], v156 offset:3264
    v_mfma_f32_16x16x32_bf16 v[72:75], v[148:151], v[120:123], v[72:75]
    v_mfma_f32_16x16x32_bf16 v[76:79], v[148:151], v[124:127], v[76:79]
    s_waitcnt lgkmcnt(2)
    v_mfma_f32_16x16x32_bf16 v[68:71], v[152:155], v[112:115], v[68:71]
    ds_read_b64_tr_b16 v[148:149], v156 offset:3784
    v_mfma_f32_16x16x32_bf16 v[72:75], v[152:155], v[116:119], v[72:75]
    ds_read_b64_tr_b16 v[150:151], v156 offset:3776
    v_mfma_f32_16x16x32_bf16 v[76:79], v[152:155], v[120:123], v[76:79]
    s_waitcnt lgkmcnt(2)
    v_mfma_f32_16x16x32_bf16 v[72:75], v[144:147], v[112:115], v[72:75]
    v_mfma_f32_16x16x32_bf16 v[76:79], v[144:147], v[116:119], v[76:79]
    s_waitcnt lgkmcnt(0)
    v_mfma_f32_16x16x32_bf16 v[76:79], v[148:151], v[112:115], v[76:79]
    v_lshlrev_b32 v158, 4, v3
    s_lshl_b32 s39, s36, 13
    s_add_u32 s39, s39, 47104
    s_cmp_eq_u32 s36, 0
    s_cselect_b32 s39, 0, s39
    v_add_u32 v5, s39, v158
    ds_write_b128 v5, v[48:51] offset:0
    ds_write_b128 v5, v[52:55] offset:1024
    ds_write_b128 v5, v[56:59] offset:2048
    ds_write_b128 v5, v[60:63] offset:3072
    ds_write_b128 v5, v[64:67] offset:4096
    ds_write_b128 v5, v[68:71] offset:5120
    ds_write_b128 v5, v[72:75] offset:6144
    ds_write_b128 v5, v[76:79] offset:7168
    s_waitcnt lgkmcnt(0)
    s_barrier
    s_lshl_b32 s39, s36, 11
    v_add_u32 v5, s39, v158
    v_add_u32 v159, 55296, v5
    ds_read_b128 v[80:83], v5 offset:0
    ds_read_b128 v[84:87], v159 offset:0
    ds_read_b128 v[88:91], v159 offset:8192
    ds_read_b128 v[92:95], v159 offset:16384
    ds_read_b128 v[112:115], v5 offset:1024
    ds_read_b128 v[116:119], v159 offset:1024
    ds_read_b128 v[120:123], v159 offset:9216
    ds_read_b128 v[124:127], v159 offset:17408
    v_lshlrev_b32 v6, 4, v3
    s_lshl_b32 s39, s3, 13
    s_lshl_b32 s40, s36, 11
    s_add_u32 s39, s39, s40
    s_add_u32 s39, s39, 11010048
    s_waitcnt lgkmcnt(4)
    v_add_f32 v80, v80, v84
    v_add_f32 v88, v88, v92
    v_add_f32 v81, v81, v85
    v_add_f32 v89, v89, v93
    v_add_f32 v82, v82, v86
    v_add_f32 v90, v90, v94
    v_add_f32 v83, v83, v87
    v_add_f32 v91, v91, v95
    v_cvt_pk_bf16_f32 v84, v80, v88
    v_cvt_pk_bf16_f32 v85, v81, v89
    v_cvt_pk_bf16_f32 v86, v82, v90
    v_cvt_pk_bf16_f32 v87, v83, v91
    buffer_store_dwordx4 v[84:87], v6, s[32:35], s39 offen offset:0 sc1
    s_waitcnt lgkmcnt(0)
    v_add_f32 v112, v112, v116
    v_add_f32 v120, v120, v124
    v_add_f32 v113, v113, v117
    v_add_f32 v121, v121, v125
    v_add_f32 v114, v114, v118
    v_add_f32 v122, v122, v126
    v_add_f32 v115, v115, v119
    v_add_f32 v123, v123, v127
    v_cvt_pk_bf16_f32 v116, v112, v120
    v_cvt_pk_bf16_f32 v117, v113, v121
    v_cvt_pk_bf16_f32 v118, v114, v122
    v_cvt_pk_bf16_f32 v119, v115, v123
    buffer_store_dwordx4 v[116:119], v6, s[32:35], s39 offen offset:1024 sc1
    s_waitcnt vmcnt(0)
    s_barrier
    s_cmp_lg_u32 s36, 0
    s_cbranch_scc1 L_y_pub_4
    s_lshr_b32 s39, s3, 5
    s_lshl_b32 s39, s39, 7
    s_add_u32 s39, s39, 12986368
    v_mov_b32 v5, s39
    s_mov_b64 exec, 1
    global_atomic_add v5, v35, s[32:33] sc1
    s_mov_b64 exec, -1
L_y_pub_4:
    s_endpgm
L_s_end:
L_a:
    s_getpc_b64 s[4:5]
L_a_pc:
    v_lshlrev_b32 v1, 7, v0
    v_cmp_gt_u32 vcc, 64, v0
    s_nop 0
    s_and_saveexec_b64 s[6:7], vcc
    s_cbranch_execz L_a_pf
    v_min_u32 v1, L_a_end-L_a_pc-4, v1
    global_load_dword v2, v1, s[4:5]
L_a_pf:
    s_mov_b64 exec, s[6:7]
L_a_nopf:
    s_setprio 3
    s_and_b32 s40, s3, 3
    s_lshl_b32 s40, s40, 4
    s_bfe_u32 s41, s3, 0x10002
    s_lshl_b32 s41, s41, 3
    s_add_u32 s40, s40, s41
    s_lshr_b32 s41, s3, 3
    s_add_u32 s3, s40, s41
    v_lshrrev_b32 v4, 6, v0
    v_and_b32 v3, 63, v0
    v_readfirstlane_b32 s16, v4
    v_lshrrev_b32 v8, 3, v0
    v_and_b32 v5, 7, v0
    v_mul_u32_u24 v6, 896, v8
    v_lshl_add_u32 v6, v5, 4, v6
    s_mul_i32 s17, s3, 28672
    s_mov_b32 s19, 0xffff0000
    s_waitcnt lgkmcnt(0)
    s_mov_b64 s[8:9], s[64:65]
    s_mov_b64 s[12:13], s[62:63]
    s_mov_b64 s[32:33], s[94:95]
    s_mov_b64 s[24:25], s[84:85]
    s_mov_b64 s[28:29], s[88:89]
    s_mov_b32 s10, 1835008
    s_mov_b32 s11, 0x20000
    s_mov_b32 s14, 12988416
    s_mov_b32 s15, 0x20000
    s_mov_b32 s26, 1605632
    s_mov_b32 s27, 0x20000
    s_mov_b32 s30, 1605632
    s_mov_b32 s31, 0x20000
    buffer_load_dwordx4 v[12:15], v6, s[8:11], s17 offen offset:0
    buffer_load_dwordx4 v[16:19], v6, s[8:11], s17 offen offset:128
    buffer_load_dwordx4 v[20:23], v6, s[8:11], s17 offen offset:256
    buffer_load_dwordx4 v[24:27], v6, s[8:11], s17 offen offset:384
    buffer_load_dwordx4 v[28:31], v6, s[8:11], s17 offen offset:512
    buffer_load_dwordx4 v[32:35], v6, s[8:11], s17 offen offset:640
    buffer_load_dwordx4 v[36:39], v6, s[8:11], s17 offen offset:768
    s_cmp_lg_u32 s16, 0
    s_cbranch_scc1 L_clr_5
    v_mov_b32 v4, 0
    s_and_b32 s18, s3, 3
    s_cmp_lg_u32 s18, 0
    s_cbranch_scc1 L_clr_6
    s_lshr_b32 s17, s3, 2
    s_lshl_b32 s17, s17, 7
    s_add_u32 s17, s17, 12984320
    s_mov_b64 exec, 1
    buffer_store_dword v4, v4, s[12:15], s17 offen sc1
    s_mov_b64 exec, -1
L_clr_6:
    s_cmp_ge_u32 s3, 7
    s_cbranch_scc1 L_clr_5
    s_lshl_b32 s18, s3, 7
    s_add_u32 s18, s18, 12986368
    s_mov_b64 exec, 1
    buffer_store_dword v4, v4, s[12:15], s18 offen sc1
    s_mov_b64 exec, -1
L_clr_5:
    s_lshr_b32 s34, s3, 3
    s_lshl_b32 s34, s34, 2
    s_add_u32 s34, s34, s16
    s_and_b32 s35, s3, 7
    v_mul_u32_u24 v114, 912, v8
    v_lshl_add_u32 v114, v5, 4, v114
    v_mov_b32 v10, 1
    s_waitcnt vmcnt(6)
    v_lshlrev_b32 v40, 16, v12
    v_and_b32 v41, 0xffff0000, v12
    v_lshlrev_b32 v42, 16, v13
    v_and_b32 v43, 0xffff0000, v13
    v_lshlrev_b32 v44, 16, v14
    v_and_b32 v45, 0xffff0000, v14
    v_lshlrev_b32 v46, 16, v15
    v_and_b32 v47, 0xffff0000, v15
    s_waitcnt vmcnt(5)
    v_lshlrev_b32 v48, 16, v16
    v_and_b32 v49, 0xffff0000, v16
    v_lshlrev_b32 v50, 16, v17
    v_and_b32 v51, 0xffff0000, v17
    v_lshlrev_b32 v52, 16, v18
    v_and_b32 v53, 0xffff0000, v18
    v_lshlrev_b32 v54, 16, v19
    v_and_b32 v55, 0xffff0000, v19
    s_waitcnt vmcnt(4)
    v_lshlrev_b32 v56, 16, v20
    v_and_b32 v57, 0xffff0000, v20
    v_lshlrev_b32 v58, 16, v21
    v_and_b32 v59, 0xffff0000, v21
    v_lshlrev_b32 v60, 16, v22
    v_and_b32 v61, 0xffff0000, v22
    v_lshlrev_b32 v62, 16, v23
    v_and_b32 v63, 0xffff0000, v23
    s_waitcnt vmcnt(3)
    v_lshlrev_b32 v64, 16, v24
    v_and_b32 v65, 0xffff0000, v24
    v_lshlrev_b32 v66, 16, v25
    v_and_b32 v67, 0xffff0000, v25
    v_lshlrev_b32 v68, 16, v26
    v_and_b32 v69, 0xffff0000, v26
    v_lshlrev_b32 v70, 16, v27
    v_and_b32 v71, 0xffff0000, v27
    s_waitcnt vmcnt(2)
    v_lshlrev_b32 v72, 16, v28
    v_and_b32 v73, 0xffff0000, v28
    v_lshlrev_b32 v74, 16, v29
    v_and_b32 v75, 0xffff0000, v29
    v_lshlrev_b32 v76, 16, v30
    v_and_b32 v77, 0xffff0000, v30
    v_lshlrev_b32 v78, 16, v31
    v_and_b32 v79, 0xffff0000, v31
    s_waitcnt vmcnt(1)
    v_lshlrev_b32 v80, 16, v32
    v_and_b32 v81, 0xffff0000, v32
    v_lshlrev_b32 v82, 16, v33
    v_and_b32 v83, 0xffff0000, v33
    v_lshlrev_b32 v84, 16, v34
    v_and_b32 v85, 0xffff0000, v34
    v_lshlrev_b32 v86, 16, v35
    v_and_b32 v87, 0xffff0000, v35
    s_waitcnt vmcnt(0)
    v_lshlrev_b32 v88, 16, v36
    v_and_b32 v89, 0xffff0000, v36
    v_lshlrev_b32 v90, 16, v37
    v_and_b32 v91, 0xffff0000, v37
    v_lshlrev_b32 v92, 16, v38
    v_and_b32 v93, 0xffff0000, v38
    v_lshlrev_b32 v94, 16, v39
    v_and_b32 v95, 0xffff0000, v39
    v_pk_add_f32 v[96:97], v[40:41], v[48:49]
    v_pk_add_f32 v[98:99], v[42:43], v[50:51]
    v_pk_add_f32 v[100:101], v[44:45], v[52:53]
    v_pk_add_f32 v[102:103], v[46:47], v[54:55]
    v_pk_add_f32 v[96:97], v[96:97], v[56:57]
    v_pk_add_f32 v[98:99], v[98:99], v[58:59]
    v_pk_add_f32 v[100:101], v[100:101], v[60:61]
    v_pk_add_f32 v[102:103], v[102:103], v[62:63]
    v_pk_add_f32 v[96:97], v[96:97], v[64:65]
    v_pk_add_f32 v[98:99], v[98:99], v[66:67]
    v_pk_add_f32 v[100:101], v[100:101], v[68:69]
    v_pk_add_f32 v[102:103], v[102:103], v[70:71]
    v_pk_add_f32 v[96:97], v[96:97], v[72:73]
    v_pk_add_f32 v[98:99], v[98:99], v[74:75]
    v_pk_add_f32 v[100:101], v[100:101], v[76:77]
    v_pk_add_f32 v[102:103], v[102:103], v[78:79]
    v_pk_add_f32 v[96:97], v[96:97], v[80:81]
    v_pk_add_f32 v[98:99], v[98:99], v[82:83]
    v_pk_add_f32 v[100:101], v[100:101], v[84:85]
    v_pk_add_f32 v[102:103], v[102:103], v[86:87]
    v_pk_add_f32 v[96:97], v[96:97], v[88:89]
    v_pk_add_f32 v[98:99], v[98:99], v[90:91]
    v_pk_add_f32 v[100:101], v[100:101], v[92:93]
    v_pk_add_f32 v[102:103], v[102:103], v[94:95]
    v_pk_add_f32 v[96:97], v[96:97], v[98:99]
    v_pk_add_f32 v[100:101], v[100:101], v[102:103]
    v_pk_add_f32 v[96:97], v[96:97], v[100:101]
    v_add_f32 v4, v96, v97
    s_nop 1
    v_add_f32 v4, v4, v4 quad_perm:[1,0,3,2] row_mask:0xf bank_mask:0xf
    s_nop 1
    v_add_f32 v4, v4, v4 quad_perm:[2,3,0,1] row_mask:0xf bank_mask:0xf
    s_nop 1
    v_add_f32 v4, v4, v4 row_half_mirror row_mask:0xf bank_mask:0xf
    v_mul_f32 v104, 0x3b124925, v4
    v_pk_add_f32 v[12:13], v[40:41], v[104:105] op_sel_hi:[1,0] neg_lo:[0,1] neg_hi:[0,1]
    v_pk_add_f32 v[14:15], v[42:43], v[104:105] op_sel_hi:[1,0] neg_lo:[0,1] neg_hi:[0,1]
    v_pk_add_f32 v[16:17], v[44:45], v[104:105] op_sel_hi:[1,0] neg_lo:[0,1] neg_hi:[0,1]
    v_pk_add_f32 v[18:19], v[46:47], v[104:105] op_sel_hi:[1,0] neg_lo:[0,1] neg_hi:[0,1]
    v_pk_mul_f32 v[96:97], v[12:13], v[12:13]
    v_pk_mul_f32 v[98:99], v[14:15], v[14:15]
    v_pk_mul_f32 v[100:101], v[16:17], v[16:17]
    v_pk_mul_f32 v[102:103], v[18:19], v[18:19]
    v_pk_add_f32 v[12:13], v[48:49], v[104:105] op_sel_hi:[1,0] neg_lo:[0,1] neg_hi:[0,1]
    v_pk_add_f32 v[14:15], v[50:51], v[104:105] op_sel_hi:[1,0] neg_lo:[0,1] neg_hi:[0,1]
    v_pk_add_f32 v[16:17], v[52:53], v[104:105] op_sel_hi:[1,0] neg_lo:[0,1] neg_hi:[0,1]
    v_pk_add_f32 v[18:19], v[54:55], v[104:105] op_sel_hi:[1,0] neg_lo:[0,1] neg_hi:[0,1]
    v_pk_fma_f32 v[96:97], v[12:13], v[12:13], v[96:97]
    v_pk_fma_f32 v[98:99], v[14:15], v[14:15], v[98:99]
    v_pk_fma_f32 v[100:101], v[16:17], v[16:17], v[100:101]
    v_pk_fma_f32 v[102:103], v[18:19], v[18:19], v[102:103]
    v_pk_add_f32 v[12:13], v[56:57], v[104:105] op_sel_hi:[1,0] neg_lo:[0,1] neg_hi:[0,1]
    v_pk_add_f32 v[14:15], v[58:59], v[104:105] op_sel_hi:[1,0] neg_lo:[0,1] neg_hi:[0,1]
    v_pk_add_f32 v[16:17], v[60:61], v[104:105] op_sel_hi:[1,0] neg_lo:[0,1] neg_hi:[0,1]
    v_pk_add_f32 v[18:19], v[62:63], v[104:105] op_sel_hi:[1,0] neg_lo:[0,1] neg_hi:[0,1]
    v_pk_fma_f32 v[96:97], v[12:13], v[12:13], v[96:97]
    v_pk_fma_f32 v[98:99], v[14:15], v[14:15], v[98:99]
    v_pk_fma_f32 v[100:101], v[16:17], v[16:17], v[100:101]
    v_pk_fma_f32 v[102:103], v[18:19], v[18:19], v[102:103]
    v_pk_add_f32 v[12:13], v[64:65], v[104:105] op_sel_hi:[1,0] neg_lo:[0,1] neg_hi:[0,1]
    v_pk_add_f32 v[14:15], v[66:67], v[104:105] op_sel_hi:[1,0] neg_lo:[0,1] neg_hi:[0,1]
    v_pk_add_f32 v[16:17], v[68:69], v[104:105] op_sel_hi:[1,0] neg_lo:[0,1] neg_hi:[0,1]
    v_pk_add_f32 v[18:19], v[70:71], v[104:105] op_sel_hi:[1,0] neg_lo:[0,1] neg_hi:[0,1]
    v_pk_fma_f32 v[96:97], v[12:13], v[12:13], v[96:97]
    v_pk_fma_f32 v[98:99], v[14:15], v[14:15], v[98:99]
    v_pk_fma_f32 v[100:101], v[16:17], v[16:17], v[100:101]
    v_pk_fma_f32 v[102:103], v[18:19], v[18:19], v[102:103]
    v_pk_add_f32 v[12:13], v[72:73], v[104:105] op_sel_hi:[1,0] neg_lo:[0,1] neg_hi:[0,1]
    v_pk_add_f32 v[14:15], v[74:75], v[104:105] op_sel_hi:[1,0] neg_lo:[0,1] neg_hi:[0,1]
    v_pk_add_f32 v[16:17], v[76:77], v[104:105] op_sel_hi:[1,0] neg_lo:[0,1] neg_hi:[0,1]
    v_pk_add_f32 v[18:19], v[78:79], v[104:105] op_sel_hi:[1,0] neg_lo:[0,1] neg_hi:[0,1]
    v_pk_fma_f32 v[96:97], v[12:13], v[12:13], v[96:97]
    v_pk_fma_f32 v[98:99], v[14:15], v[14:15], v[98:99]
    v_pk_fma_f32 v[100:101], v[16:17], v[16:17], v[100:101]
    v_pk_fma_f32 v[102:103], v[18:19], v[18:19], v[102:103]
    v_pk_add_f32 v[12:13], v[80:81], v[104:105] op_sel_hi:[1,0] neg_lo:[0,1] neg_hi:[0,1]
    v_pk_add_f32 v[14:15], v[82:83], v[104:105] op_sel_hi:[1,0] neg_lo:[0,1] neg_hi:[0,1]
    v_pk_add_f32 v[16:17], v[84:85], v[104:105] op_sel_hi:[1,0] neg_lo:[0,1] neg_hi:[0,1]
    v_pk_add_f32 v[18:19], v[86:87], v[104:105] op_sel_hi:[1,0] neg_lo:[0,1] neg_hi:[0,1]
    v_pk_fma_f32 v[96:97], v[12:13], v[12:13], v[96:97]
    v_pk_fma_f32 v[98:99], v[14:15], v[14:15], v[98:99]
    v_pk_fma_f32 v[100:101], v[16:17], v[16:17], v[100:101]
    v_pk_fma_f32 v[102:103], v[18:19], v[18:19], v[102:103]
    v_pk_add_f32 v[12:13], v[88:89], v[104:105] op_sel_hi:[1,0] neg_lo:[0,1] neg_hi:[0,1]
    v_pk_add_f32 v[14:15], v[90:91], v[104:105] op_sel_hi:[1,0] neg_lo:[0,1] neg_hi:[0,1]
    v_pk_add_f32 v[16:17], v[92:93], v[104:105] op_sel_hi:[1,0] neg_lo:[0,1] neg_hi:[0,1]
    v_pk_add_f32 v[18:19], v[94:95], v[104:105] op_sel_hi:[1,0] neg_lo:[0,1] neg_hi:[0,1]
    v_pk_fma_f32 v[96:97], v[12:13], v[12:13], v[96:97]
    v_pk_fma_f32 v[98:99], v[14:15], v[14:15], v[98:99]
    v_pk_fma_f32 v[100:101], v[16:17], v[16:17], v[100:101]
    v_pk_fma_f32 v[102:103], v[18:19], v[18:19], v[102:103]
    v_pk_add_f32 v[96:97], v[96:97], v[98:99]
    v_pk_add_f32 v[100:101], v[100:101], v[102:103]
    v_pk_add_f32 v[96:97], v[96:97], v[100:101]
    v_add_f32 v5, v96, v97
    s_nop 1
    v_add_f32 v5, v5, v5 quad_perm:[1,0,3,2] row_mask:0xf bank_mask:0xf
    s_nop 1
    v_add_f32 v5, v5, v5 quad_perm:[2,3,0,1] row_mask:0xf bank_mask:0xf
    s_nop 1
    v_add_f32 v5, v5, v5 row_half_mirror row_mask:0xf bank_mask:0xf
    v_mul_f32 v5, 0x3b124925, v5
    v_cvt_pk_bf16_f32 v6, v104, v5
    v_lshlrev_b32 v104, 16, v6
    v_and_b32 v5, 0xffff0000, v6
    v_add_f32 v5, 0x3727c5ac, v5
    v_cvt_pk_bf16_f32 v5, v5, v5
    v_and_b32 v5, 0xffff0000, v5
    v_sqrt_f32 v5, v5
    s_nop 0
    v_cvt_pk_bf16_f32 v5, v5, v5
    v_and_b32 v5, 0xffff0000, v5
    v_rcp_f32 v105, v5
    v_xor_b32 v6, 0x80000000, v104
    v_lshrrev_b32 v7, 16, v6
    v_and_or_b32 v116, v6, s19, v7
    v_lshrrev_b32 v117, 16, v5
    v_mov_b32 v118, 0
    v_mov_b32 v119, 0
    v_mov_b32 v120, 0
    v_mov_b32 v121, 0
    v_mov_b32 v122, 0
    v_mov_b32 v123, 0
    s_lshl_b32 s17, s3, 8
    s_add_u32 s17, s17, 12845056
    v_lshlrev_b32 v6, 3, v8
    v_and_b32 v7, 7, v3
    v_cmp_eq_u32 vcc, 0, v7
    s_nop 0
    s_and_saveexec_b64 s[20:21], vcc
    buffer_store_dwordx2 v[104:105], v6, s[12:15], s17 offen sc1
    s_lshl_b32 s17, s3, 10
    s_add_u32 s17, s17, 12918784
    v_lshlrev_b32 v6, 4, v8
    buffer_store_dwordx4 v[116:119], v6, s[12:15], s17 offen sc1
    buffer_store_dwordx4 v[120:123], v6, s[12:15], s17 offen offset:512 sc1
    s_mov_b64 exec, s[20:21]
    v_mov_b32 v124, v105
    v_mov_b32 v125, v105
    v_pk_add_f32 v[40:41], v[40:41], v[104:105] op_sel_hi:[1,0] neg_lo:[0,1] neg_hi:[0,1]
    v_pk_add_f32 v[42:43], v[42:43], v[104:105] op_sel_hi:[1,0] neg_lo:[0,1] neg_hi:[0,1]
    v_pk_add_f32 v[44:45], v[44:45], v[104:105] op_sel_hi:[1,0] neg_lo:[0,1] neg_hi:[0,1]
    v_pk_add_f32 v[46:47], v[46:47], v[104:105] op_sel_hi:[1,0] neg_lo:[0,1] neg_hi:[0,1]
    v_cvt_pk_bf16_f32 v12, v40, v41
    v_cvt_pk_bf16_f32 v13, v42, v43
    v_cvt_pk_bf16_f32 v14, v44, v45
    v_cvt_pk_bf16_f32 v15, v46, v47
    v_lshlrev_b32 v40, 16, v12
    v_and_b32 v41, 0xffff0000, v12
    v_lshlrev_b32 v42, 16, v13
    v_and_b32 v43, 0xffff0000, v13
    v_lshlrev_b32 v44, 16, v14
    v_and_b32 v45, 0xffff0000, v14
    v_lshlrev_b32 v46, 16, v15
    v_and_b32 v47, 0xffff0000, v15
    v_pk_mul_f32 v[40:41], v[40:41], v[124:125]
    v_pk_mul_f32 v[42:43], v[42:43], v[124:125]
    v_pk_mul_f32 v[44:45], v[44:45], v[124:125]
    v_pk_mul_f32 v[46:47], v[46:47], v[124:125]
    v_cvt_pk_bf16_f32 v20, v40, v41
    v_cvt_pk_bf16_f32 v21, v42, v43
    v_cvt_pk_bf16_f32 v22, v44, v45
    v_cvt_pk_bf16_f32 v23, v46, v47
    ds_write_b128 v114, v[20:23] offset:0
    v_pk_add_f32 v[48:49], v[48:49], v[104:105] op_sel_hi:[1,0] neg_lo:[0,1] neg_hi:[0,1]
    v_pk_add_f32 v[50:51], v[50:51], v[104:105] op_sel_hi:[1,0] neg_lo:[0,1] neg_hi:[0,1]
    v_pk_add_f32 v[52:53], v[52:53], v[104:105] op_sel_hi:[1,0] neg_lo:[0,1] neg_hi:[0,1]
    v_pk_add_f32 v[54:55], v[54:55], v[104:105] op_sel_hi:[1,0] neg_lo:[0,1] neg_hi:[0,1]
    v_cvt_pk_bf16_f32 v12, v48, v49
    v_cvt_pk_bf16_f32 v13, v50, v51
    v_cvt_pk_bf16_f32 v14, v52, v53
    v_cvt_pk_bf16_f32 v15, v54, v55
    v_lshlrev_b32 v48, 16, v12
    v_and_b32 v49, 0xffff0000, v12
    v_lshlrev_b32 v50, 16, v13
    v_and_b32 v51, 0xffff0000, v13
    v_lshlrev_b32 v52, 16, v14
    v_and_b32 v53, 0xffff0000, v14
    v_lshlrev_b32 v54, 16, v15
    v_and_b32 v55, 0xffff0000, v15
    v_pk_mul_f32 v[48:49], v[48:49], v[124:125]
    v_pk_mul_f32 v[50:51], v[50:51], v[124:125]
    v_pk_mul_f32 v[52:53], v[52:53], v[124:125]
    v_pk_mul_f32 v[54:55], v[54:55], v[124:125]
    v_cvt_pk_bf16_f32 v24, v48, v49
    v_cvt_pk_bf16_f32 v25, v50, v51
    v_cvt_pk_bf16_f32 v26, v52, v53
    v_cvt_pk_bf16_f32 v27, v54, v55
    ds_write_b128 v114, v[24:27] offset:128
    v_pk_add_f32 v[56:57], v[56:57], v[104:105] op_sel_hi:[1,0] neg_lo:[0,1] neg_hi:[0,1]
    v_pk_add_f32 v[58:59], v[58:59], v[104:105] op_sel_hi:[1,0] neg_lo:[0,1] neg_hi:[0,1]
    v_pk_add_f32 v[60:61], v[60:61], v[104:105] op_sel_hi:[1,0] neg_lo:[0,1] neg_hi:[0,1]
    v_pk_add_f32 v[62:63], v[62:63], v[104:105] op_sel_hi:[1,0] neg_lo:[0,1] neg_hi:[0,1]
    v_cvt_pk_bf16_f32 v12, v56, v57
    v_cvt_pk_bf16_f32 v13, v58, v59
    v_cvt_pk_bf16_f32 v14, v60, v61
    v_cvt_pk_bf16_f32 v15, v62, v63
    v_lshlrev_b32 v56, 16, v12
    v_and_b32 v57, 0xffff0000, v12
    v_lshlrev_b32 v58, 16, v13
    v_and_b32 v59, 0xffff0000, v13
    v_lshlrev_b32 v60, 16, v14
    v_and_b32 v61, 0xffff0000, v14
    v_lshlrev_b32 v62, 16, v15
    v_and_b32 v63, 0xffff0000, v15
    v_pk_mul_f32 v[56:57], v[56:57], v[124:125]
    v_pk_mul_f32 v[58:59], v[58:59], v[124:125]
    v_pk_mul_f32 v[60:61], v[60:61], v[124:125]
    v_pk_mul_f32 v[62:63], v[62:63], v[124:125]
    v_cvt_pk_bf16_f32 v20, v56, v57
    v_cvt_pk_bf16_f32 v21, v58, v59
    v_cvt_pk_bf16_f32 v22, v60, v61
    v_cvt_pk_bf16_f32 v23, v62, v63
    ds_write_b128 v114, v[20:23] offset:256
    v_pk_add_f32 v[64:65], v[64:65], v[104:105] op_sel_hi:[1,0] neg_lo:[0,1] neg_hi:[0,1]
    v_pk_add_f32 v[66:67], v[66:67], v[104:105] op_sel_hi:[1,0] neg_lo:[0,1] neg_hi:[0,1]
    v_pk_add_f32 v[68:69], v[68:69], v[104:105] op_sel_hi:[1,0] neg_lo:[0,1] neg_hi:[0,1]
    v_pk_add_f32 v[70:71], v[70:71], v[104:105] op_sel_hi:[1,0] neg_lo:[0,1] neg_hi:[0,1]
    v_cvt_pk_bf16_f32 v12, v64, v65
    v_cvt_pk_bf16_f32 v13, v66, v67
    v_cvt_pk_bf16_f32 v14, v68, v69
    v_cvt_pk_bf16_f32 v15, v70, v71
    v_lshlrev_b32 v64, 16, v12
    v_and_b32 v65, 0xffff0000, v12
    v_lshlrev_b32 v66, 16, v13
    v_and_b32 v67, 0xffff0000, v13
    v_lshlrev_b32 v68, 16, v14
    v_and_b32 v69, 0xffff0000, v14
    v_lshlrev_b32 v70, 16, v15
    v_and_b32 v71, 0xffff0000, v15
    v_pk_mul_f32 v[64:65], v[64:65], v[124:125]
    v_pk_mul_f32 v[66:67], v[66:67], v[124:125]
    v_pk_mul_f32 v[68:69], v[68:69], v[124:125]
    v_pk_mul_f32 v[70:71], v[70:71], v[124:125]
    v_cvt_pk_bf16_f32 v24, v64, v65
    v_cvt_pk_bf16_f32 v25, v66, v67
    v_cvt_pk_bf16_f32 v26, v68, v69
    v_cvt_pk_bf16_f32 v27, v70, v71
    ds_write_b128 v114, v[24:27] offset:384
    v_pk_add_f32 v[72:73], v[72:73], v[104:105] op_sel_hi:[1,0] neg_lo:[0,1] neg_hi:[0,1]
    v_pk_add_f32 v[74:75], v[74:75], v[104:105] op_sel_hi:[1,0] neg_lo:[0,1] neg_hi:[0,1]
    v_pk_add_f32 v[76:77], v[76:77], v[104:105] op_sel_hi:[1,0] neg_lo:[0,1] neg_hi:[0,1]
    v_pk_add_f32 v[78:79], v[78:79], v[104:105] op_sel_hi:[1,0] neg_lo:[0,1] neg_hi:[0,1]
    v_cvt_pk_bf16_f32 v12, v72, v73
    v_cvt_pk_bf16_f32 v13, v74, v75
    v_cvt_pk_bf16_f32 v14, v76, v77
    v_cvt_pk_bf16_f32 v15, v78, v79
    v_lshlrev_b32 v72, 16, v12
    v_and_b32 v73, 0xffff0000, v12
    v_lshlrev_b32 v74, 16, v13
    v_and_b32 v75, 0xffff0000, v13
    v_lshlrev_b32 v76, 16, v14
    v_and_b32 v77, 0xffff0000, v14
    v_lshlrev_b32 v78, 16, v15
    v_and_b32 v79, 0xffff0000, v15
    v_pk_mul_f32 v[72:73], v[72:73], v[124:125]
    v_pk_mul_f32 v[74:75], v[74:75], v[124:125]
    v_pk_mul_f32 v[76:77], v[76:77], v[124:125]
    v_pk_mul_f32 v[78:79], v[78:79], v[124:125]
    v_cvt_pk_bf16_f32 v20, v72, v73
    v_cvt_pk_bf16_f32 v21, v74, v75
    v_cvt_pk_bf16_f32 v22, v76, v77
    v_cvt_pk_bf16_f32 v23, v78, v79
    ds_write_b128 v114, v[20:23] offset:512
    v_pk_add_f32 v[80:81], v[80:81], v[104:105] op_sel_hi:[1,0] neg_lo:[0,1] neg_hi:[0,1]
    v_pk_add_f32 v[82:83], v[82:83], v[104:105] op_sel_hi:[1,0] neg_lo:[0,1] neg_hi:[0,1]
    v_pk_add_f32 v[84:85], v[84:85], v[104:105] op_sel_hi:[1,0] neg_lo:[0,1] neg_hi:[0,1]
    v_pk_add_f32 v[86:87], v[86:87], v[104:105] op_sel_hi:[1,0] neg_lo:[0,1] neg_hi:[0,1]
    v_cvt_pk_bf16_f32 v12, v80, v81
    v_cvt_pk_bf16_f32 v13, v82, v83
    v_cvt_pk_bf16_f32 v14, v84, v85
    v_cvt_pk_bf16_f32 v15, v86, v87
    v_lshlrev_b32 v80, 16, v12
    v_and_b32 v81, 0xffff0000, v12
    v_lshlrev_b32 v82, 16, v13
    v_and_b32 v83, 0xffff0000, v13
    v_lshlrev_b32 v84, 16, v14
    v_and_b32 v85, 0xffff0000, v14
    v_lshlrev_b32 v86, 16, v15
    v_and_b32 v87, 0xffff0000, v15
    v_pk_mul_f32 v[80:81], v[80:81], v[124:125]
    v_pk_mul_f32 v[82:83], v[82:83], v[124:125]
    v_pk_mul_f32 v[84:85], v[84:85], v[124:125]
    v_pk_mul_f32 v[86:87], v[86:87], v[124:125]
    v_cvt_pk_bf16_f32 v24, v80, v81
    v_cvt_pk_bf16_f32 v25, v82, v83
    v_cvt_pk_bf16_f32 v26, v84, v85
    v_cvt_pk_bf16_f32 v27, v86, v87
    ds_write_b128 v114, v[24:27] offset:640
    v_pk_add_f32 v[88:89], v[88:89], v[104:105] op_sel_hi:[1,0] neg_lo:[0,1] neg_hi:[0,1]
    v_pk_add_f32 v[90:91], v[90:91], v[104:105] op_sel_hi:[1,0] neg_lo:[0,1] neg_hi:[0,1]
    v_pk_add_f32 v[92:93], v[92:93], v[104:105] op_sel_hi:[1,0] neg_lo:[0,1] neg_hi:[0,1]
    v_pk_add_f32 v[94:95], v[94:95], v[104:105] op_sel_hi:[1,0] neg_lo:[0,1] neg_hi:[0,1]
    v_cvt_pk_bf16_f32 v12, v88, v89
    v_cvt_pk_bf16_f32 v13, v90, v91
    v_cvt_pk_bf16_f32 v14, v92, v93
    v_cvt_pk_bf16_f32 v15, v94, v95
    v_lshlrev_b32 v88, 16, v12
    v_and_b32 v89, 0xffff0000, v12
    v_lshlrev_b32 v90, 16, v13
    v_and_b32 v91, 0xffff0000, v13
    v_lshlrev_b32 v92, 16, v14
    v_and_b32 v93, 0xffff0000, v14
    v_lshlrev_b32 v94, 16, v15
    v_and_b32 v95, 0xffff0000, v15
    v_pk_mul_f32 v[88:89], v[88:89], v[124:125]
    v_pk_mul_f32 v[90:91], v[90:91], v[124:125]
    v_pk_mul_f32 v[92:93], v[92:93], v[124:125]
    v_pk_mul_f32 v[94:95], v[94:95], v[124:125]
    v_cvt_pk_bf16_f32 v20, v88, v89
    v_cvt_pk_bf16_f32 v21, v90, v91
    v_cvt_pk_bf16_f32 v22, v92, v93
    v_cvt_pk_bf16_f32 v23, v94, v95
    ds_write_b128 v114, v[20:23] offset:768
    s_waitcnt lgkmcnt(0) vmcnt(0)
    s_barrier
    s_cmp_lg_u32 s16, 0
    s_cbranch_scc1 L_aux_arr_7
    v_mov_b32 v7, 0
    s_mov_b64 exec, 1
    global_atomic_add v11, v7, v10, s[32:33] sc0 sc1
    s_mov_b64 exec, -1
L_aux_arr_7:
    v_lshrrev_b32 v4, 4, v3
    v_bfe_u32 v5, v3, 2, 2
    v_lshl_add_u32 v5, v4, 3, v5
    v_mul_u32_u24 v5, 912, v5
    v_and_b32 v6, 3, v3
    v_lshl_add_u32 v5, v6, 3, v5
    s_lshl_b32 s17, s16, 5
    v_add_u32 v5, s17, v5
    v_lshlrev_b32 v6, 4, v3
    s_mul_i32 s17, s3, 28672
    s_lshl_b32 s18, s16, 10
    s_add_u32 s17, s17, s18
    s_add_u32 s17, s17, 7340032
    ds_read_b64_tr_b16 v[40:41], v5 offset:0
    ds_read_b64_tr_b16 v[42:43], v5 offset:3648
    ds_read_b64_tr_b16 v[44:45], v5 offset:128
    ds_read_b64_tr_b16 v[46:47], v5 offset:3776
    ds_read_b64_tr_b16 v[48:49], v5 offset:256
    ds_read_b64_tr_b16 v[50:51], v5 offset:3904
    ds_read_b64_tr_b16 v[52:53], v5 offset:384
    ds_read_b64_tr_b16 v[54:55], v5 offset:4032
    ds_read_b64_tr_b16 v[56:57], v5 offset:512
    ds_read_b64_tr_b16 v[58:59], v5 offset:4160
    ds_read_b64_tr_b16 v[60:61], v5 offset:640
    ds_read_b64_tr_b16 v[62:63], v5 offset:4288
    ds_read_b64_tr_b16 v[64:65], v5 offset:768
    ds_read_b64_tr_b16 v[66:67], v5 offset:4416
    s_waitcnt lgkmcnt(12)
    buffer_store_dwordx4 v[40:43], v6, s[12:15], s17 offen sc1
    s_add_u32 s17, s17, 4096
    s_waitcnt lgkmcnt(10)
    buffer_store_dwordx4 v[44:47], v6, s[12:15], s17 offen sc1
    s_add_u32 s17, s17, 4096
    s_waitcnt lgkmcnt(8)
    buffer_store_dwordx4 v[48:51], v6, s[12:15], s17 offen sc1
    s_add_u32 s17, s17, 4096
    s_waitcnt lgkmcnt(6)
    buffer_store_dwordx4 v[52:55], v6, s[12:15], s17 offen sc1
    s_add_u32 s17, s17, 4096
    s_waitcnt lgkmcnt(4)
    buffer_store_dwordx4 v[56:59], v6, s[12:15], s17 offen sc1
    s_add_u32 s17, s17, 4096
    s_waitcnt lgkmcnt(2)
    buffer_store_dwordx4 v[60:63], v6, s[12:15], s17 offen sc1
    s_add_u32 s17, s17, 4096
    s_waitcnt lgkmcnt(0)
    buffer_store_dwordx4 v[64:67], v6, s[12:15], s17 offen sc1
    s_cmp_lg_u32 s16, 0
    s_cbranch_scc1 L_aux_pub_8
    v_mov_b32 v7, 128
    s_waitcnt vmcnt(7)
    v_readfirstlane_b32 s18, v11
    s_nop 0
    s_cmp_lg_u32 s18, 63
    s_cbranch_scc1 L_notlast_9
    s_mov_b64 exec, 1
    global_store_dword v7, v10, s[32:33] sc1
    s_mov_b64 exec, -1
L_notlast_9:
L_aux_pub_8:
    s_waitcnt vmcnt(0)
    s_barrier
    s_cmp_lg_u32 s16, 0
    s_cbranch_scc1 L_xt_done_10
    v_mov_b32 v6, 4
    s_mov_b64 exec, 1
    global_atomic_add v11, v6, v10, s[32:33] sc0 sc1
    s_mov_b64 exec, -1
    v_mov_b32 v6, 192
    s_waitcnt vmcnt(0)
    v_readfirstlane_b32 s17, v11
    s_nop 0
    s_cmp_lg_u32 s17, 63
    s_cbranch_scc1 L_notlast_11
    s_mov_b64 exec, 1
    global_store_dword v6, v10, s[32:33] sc1
    s_mov_b64 exec, -1
L_notlast_11:
L_xt_done_10:
    s_endpgm
L_a_end:
L_m:
    s_getpc_b64 s[4:5]
L_m_pc:
    v_lshlrev_b32 v1, 7, v0
    v_cmp_gt_u32 vcc, 64, v0
    s_nop 0
    s_and_saveexec_b64 s[6:7], vcc
    s_cbranch_execz L_m_pf
    v_min_u32 v1, L_m_end-L_m_pc-4, v1
    global_load_dword v2, v1, s[4:5]
    v_add_u32 v1, 0x2000, v1
    v_min_u32 v1, L_m_end-L_m_pc-4, v1
    global_load_dword v2, v1, s[4:5]
    v_add_u32 v1, 0x2000, v1
    v_min_u32 v1, L_m_end-L_m_pc-4, v1
    global_load_dword v2, v1, s[4:5]
L_m_pf:
    s_mov_b64 exec, s[6:7]
L_m_nopf:
    s_setprio 2
    v_lshrrev_b32 v4, 6, v0
    v_and_b32 v3, 63, v0
    v_readfirstlane_b32 s26, v4
    s_and_b32 s32, s3, 7
    s_lshr_b32 s33, s3, 3
    s_and_b32 s24, s32, 3
    s_lshl_b32 s24, s24, 2
    s_and_b32 s34, s33, 3
    s_add_u32 s24, s24, s34
    s_lshr_b32 s32, s32, 2
    s_lshr_b32 s39, s33, 2
    s_mul_i32 s25, s32, 7
    s_add_u32 s25, s25, s39
    s_lshl_b32 s38, s24, 1
    s_add_u32 s38, s38, s32
    s_lshr_b32 s27, s26, 1
    s_and_b32 s28, s26, 1
    s_mul_i32 s29, s24, 114688
    s_mul_i32 s32, s26, 28672
    s_add_u32 s29, s29, s32
    s_lshl_b32 s30, s25, 8
    s_mul_i32 s32, s26, 28672
    s_add_u32 s30, s30, s32
    s_lshl_b32 s31, s26, 12
    s_lshl_b32 s35, s26, 11
    v_lshrrev_b32 v4, 3, v3
    v_mul_u32_u24 v4, 896, v4
    v_and_b32 v5, 7, v3
    v_lshrrev_b32 v6, 4, v3
    v_xor_b32 v7, v5, v6
    v_lshl_add_u32 v116, v7, 4, v4
    v_xor_b32 v7, 4, v7
    v_lshl_add_u32 v117, v7, 4, v4
    v_and_b32 v7, 1, v6
    v_lshlrev_b32 v7, 2, v7
    v_xor_b32 v7, v7, v5
    v_lshl_add_u32 v11, v7, 4, v4
    v_mul_u32_u24 v4, 3584, v6
    v_and_b32 v5, 15, v3
    v_lshlrev_b32 v7, 2, v6
    v_xor_b32 v5, v5, v7
    v_lshl_add_u32 v118, v5, 4, v4
    s_waitcnt lgkmcnt(0)
    s_mov_b64 s[8:9], s[64:65]
    s_mov_b64 s[12:13], s[84:85]
    s_mov_b64 s[16:17], s[62:63]
    s_mov_b64 s[40:41], s[88:89]
    s_mov_b64 s[44:45], s[92:93]
    s_mov_b64 s[48:49], s[80:81]
    s_mov_b64 s[52:53], s[90:91]
    s_mov_b64 s[56:57], s[94:95]
    s_mov_b64 s[96:97], s[86:87]
    s_mov_b32 s10, 1835008
    s_mov_b32 s11, 0x20000
    s_mov_b32 s14, 1605632
    s_mov_b32 s15, 0x20000
    s_mov_b32 s18, 12988416
    s_mov_b32 s19, 0x20000
    s_add_u32 m0, s31, 0
    s_add_u32 s32, s29, 0
    buffer_load_dwordx4 v116, s[8:11], s32 offen lds
    s_add_u32 m0, s31, 1024
    s_add_u32 s32, s29, 7168
    buffer_load_dwordx4 v117, s[8:11], s32 offen lds
    s_add_u32 m0, s31, 2048
    s_add_u32 s32, s29, 14336
    buffer_load_dwordx4 v116, s[8:11], s32 offen lds
    s_add_u32 m0, s31, 3072
    s_add_u32 s32, s29, 21504
    buffer_load_dwordx4 v117, s[8:11], s32 offen lds
    s_add_u32 m0, s35, 49152
    s_add_u32 s32, s30, 0
    buffer_load_dwordx4 v118, s[12:15], s32 offen lds
    s_add_u32 m0, s35, 50176
    s_add_u32 s32, s30, 14336
    buffer_load_dwordx4 v118, s[12:15], s32 offen lds
    s_add_u32 m0, s35, 57344
    s_add_u32 s32, s30, 114688
    buffer_load_dwordx4 v118, s[12:15], s32 offen lds
    s_add_u32 m0, s35, 58368
    s_add_u32 s32, s30, 129024
    buffer_load_dwordx4 v118, s[12:15], s32 offen lds
    s_add_u32 m0, s31, 16384
    s_add_u32 s32, s29, 128
    buffer_load_dwordx4 v116, s[8:11], s32 offen lds
    s_add_u32 m0, s31, 17408
    s_add_u32 s32, s29, 7296
    buffer_load_dwordx4 v117, s[8:11], s32 offen lds
    s_add_u32 m0, s31, 18432
    s_add_u32 s32, s29, 14464
    buffer_load_dwordx4 v116, s[8:11], s32 offen lds
    s_add_u32 m0, s31, 19456
    s_add_u32 s32, s29, 21632
    buffer_load_dwordx4 v117, s[8:11], s32 offen lds
    s_add_u32 m0, s35, 65536
    s_add_u32 s32, s30, 229376
    buffer_load_dwordx4 v118, s[12:15], s32 offen lds
    s_add_u32 m0, s35, 66560
    s_add_u32 s32, s30, 243712
    buffer_load_dwordx4 v118, s[12:15], s32 offen lds
    s_add_u32 m0, s35, 73728
    s_add_u32 s32, s30, 344064
    buffer_load_dwordx4 v118, s[12:15], s32 offen lds
    s_add_u32 m0, s35, 74752
    s_add_u32 s32, s30, 358400
    buffer_load_dwordx4 v118, s[12:15], s32 offen lds
    s_add_u32 m0, s31, 32768
    s_add_u32 s32, s29, 256
    buffer_load_dwordx4 v116, s[8:11], s32 offen lds
    s_add_u32 m0, s31, 33792
    s_add_u32 s32, s29, 7424
    buffer_load_dwordx4 v117, s[8:11], s32 offen lds
    s_add_u32 m0, s31, 34816
    s_add_u32 s32, s29, 14592
    buffer_load_dwordx4 v116, s[8:11], s32 offen lds
    s_add_u32 m0, s31, 35840
    s_add_u32 s32, s29, 21760
    buffer_load_dwordx4 v117, s[8:11], s32 offen lds
    s_lshl_b32 s32, s39, 2
    s_add_u32 s32, s32, s26
    s_mul_i32 s32, s32, 19
    v_add_u32 v4, s32, v3
    v_lshrrev_b32 v5, 2, v4
    v_mul_u32_u24 v5, 896, v5
    v_and_b32 v6, 3, v4
    v_lshl_add_u32 v5, v6, 7, v5
    v_cmp_gt_u32 vcc, 19, v3
    v_mov_b32 v6, 0x7fffff00
    s_nop 0
    v_cndmask_b32 v5, v6, v5, vcc
    v_mov_b32 v7, 0x200
    v_cmp_lt_u32 vcc, v4, v7
    s_nop 1
    v_cndmask_b32 v5, v6, v5, vcc
    s_mul_i32 s32, s24, 114688
    s_add_u32 s32, s32, 384
    buffer_load_dword v17, v5, s[8:11], s32 offen
    s_and_b32 s32, s24, 3
    s_lshl_b32 s32, s32, 2
    s_add_u32 s32, s32, s26
    s_mul_i32 s32, s32, 40
    v_add_u32 v4, s32, v3
    v_lshrrev_b32 v5, 1, v4
    v_mul_u32_u24 v5, 3584, v5
    v_and_b32 v7, 1, v4
    v_lshl_add_u32 v5, v7, 7, v5
    v_cmp_gt_u32 vcc, 40, v3
    s_nop 1
    v_cndmask_b32 v5, v6, v5, vcc
    s_lshl_b32 s32, s25, 8
    s_add_u32 s32, s32, 458752
    buffer_load_dword v18, v5, s[12:15], s32 offen
    s_mov_b32 s42, 1605632
    s_mov_b32 s43, 0x20000
    s_mov_b32 s46, 1835008
    s_mov_b32 s47, 0x20000
    s_mov_b32 s50, 896
    s_mov_b32 s51, 0x20000
    s_mov_b32 s54, 896
    s_mov_b32 s55, 0x20000
    s_mov_b32 s98, 3584
    s_mov_b32 s99, 0x20000
    v_and_b32 v4, 31, v3
    v_lshlrev_b32 v4, 1, v4
    s_xor_b32 s32, s28, 0
    s_lshl_b32 s33, s27, 1
    s_add_u32 s32, s32, s33
    s_lshl_b32 s32, s32, 6
    s_lshl_b32 s33, s25, 8
    s_add_u32 s32, s32, s33
    buffer_load_ushort v156, v4, s[96:99], s32 offen
    s_xor_b32 s32, s28, 1
    s_lshl_b32 s33, s27, 1
    s_add_u32 s32, s32, s33
    s_lshl_b32 s32, s32, 6
    s_lshl_b32 s33, s25, 8
    s_add_u32 s32, s32, s33
    buffer_load_ushort v157, v4, s[96:99], s32 offen
    v_lshrrev_b32 v4, 5, v3
    v_bfe_u32 v5, v3, 2, 2
    v_lshl_add_u32 v6, v4, 3, v5
    v_lshlrev_b32 v6, 8, v6
    v_bfe_u32 v7, v3, 4, 1
    v_lshlrev_b32 v7, 1, v7
    v_bfe_u32 v8, v3, 1, 1
    v_add_u32 v7, v7, v8
    v_lshlrev_b32 v9, 4, v7
    v_and_b32 v8, 1, v3
    v_lshl_add_u32 v9, v8, 3, v9
    v_add_u32 v6, v6, v9
    s_xor_b32 s32, s28, 0
    s_lshl_b32 s33, s27, 1
    s_add_u32 s32, s32, s33
    v_xor_b32 v7, s32, v5
    v_lshl_add_u32 v119, v7, 6, v6
    v_add_u32 v119, 49152, v119
    s_xor_b32 s32, s28, 1
    s_lshl_b32 s33, s27, 1
    s_add_u32 s32, s32, s33
    v_xor_b32 v7, s32, v5
    v_lshl_add_u32 v120, v7, 6, v6
    v_add_u32 v120, 49152, v120
    s_mul_i32 s22, s26, 20480
    v_lshl_add_u32 v6, v4, 2, v5
    v_lshl_add_u32 v6, v6, 7, v9
    v_add_u32 v6, s22, v6
    v_lshrrev_b32 v7, 1, v5
    v_lshl_add_u32 v15, v7, 6, v6
    v_xor_b32 v7, 1, v7
    v_lshl_add_u32 v16, v7, 6, v6
    v_and_b32 v5, 31, v3
    v_bfe_u32 v6, v3, 1, 3
    v_xor_b32 v6, v6, v4
    s_xor_b32 s32, s27, 0
    s_lshl_b32 s33, s28, 1
    s_add_u32 s32, s32, s33
    s_lshl_b32 s32, s32, 12
    v_lshl_add_u32 v7, v5, 7, s32
    v_xor_b32 v8, 0, v6
    v_lshl_add_u32 v121, v8, 4, v7
    v_xor_b32 v8, 2, v6
    v_lshl_add_u32 v122, v8, 4, v7
    v_xor_b32 v8, 4, v6
    v_lshl_add_u32 v123, v8, 4, v7
    v_xor_b32 v8, 6, v6
    v_lshl_add_u32 v124, v8, 4, v7
    s_xor_b32 s32, s27, 1
    s_lshl_b32 s33, s28, 1
    s_add_u32 s32, s32, s33
    s_lshl_b32 s32, s32, 12
    v_lshl_add_u32 v7, v5, 7, s32
    v_xor_b32 v8, 0, v6
    v_lshl_add_u32 v125, v8, 4, v7
    v_xor_b32 v8, 2, v6
    v_lshl_add_u32 v126, v8, 4, v7
    v_xor_b32 v8, 4, v6
    v_lshl_add_u32 v127, v8, 4, v7
    v_xor_b32 v8, 6, v6
    v_lshl_add_u32 v128, v8, 4, v7
    v_lshlrev_b32 v10, 4, v3
    v_mov_b32 v14, 1
    v_and_b32 v5, 15, v3
    v_bfe_u32 v6, v3, 4, 1
    v_cmp_eq_u32 vcc, v5, v6
    v_mov_b32 v7, 0x3f803f80
    s_nop 0
    v_cndmask_b32 v152, 0, v7, vcc
    v_mov_b32 v153, v152
    v_mov_b32 v154, v152
    v_mov_b32 v155, v152
    v_mov_b32 v12, 128
    s_mul_i32 s20, s38, 229376
    s_mul_i32 s32, s26, 28672
    s_add_u32 s20, s20, s32
    s_mul_i32 s21, s26, 401408
    s_lshl_b32 s32, s39, 7
    s_add_u32 s21, s21, s32
    s_mul_i32 s23, s38, 57344
    s_add_u32 s23, s23, s32
    s_add_u32 s59, s23, 28672
    s_waitcnt vmcnt(18)
    s_barrier
    ds_read_b64_tr_b16 v[160:161], v119 offset:0
    ds_read_b64_tr_b16 v[162:163], v119 offset:1024
    ds_read_b128 v[176:179], v121 offset:0
    ds_read_b64_tr_b16 v[164:165], v120 offset:0
    ds_read_b64_tr_b16 v[166:167], v120 offset:1024
    ds_read_b128 v[180:183], v125 offset:0
    s_waitcnt lgkmcnt(0)
    v_mfma_f32_32x32x16_bf16 v[20:35], v[160:163], v[176:179], 0
    ds_read_b64_tr_b16 v[168:169], v119 offset:4096
    ds_read_b64_tr_b16 v[170:171], v119 offset:5120
    ds_read_b128 v[184:187], v122 offset:0
    v_mfma_f32_32x32x16_bf16 v[36:51], v[160:163], v[180:183], 0
    ds_read_b64_tr_b16 v[172:173], v120 offset:4096
    ds_read_b64_tr_b16 v[174:175], v120 offset:5120
    ds_read_b128 v[188:191], v126 offset:0
    v_mfma_f32_32x32x16_bf16 v[52:67], v[164:167], v[176:179], 0
    v_mfma_f32_32x32x16_bf16 v[68:83], v[164:167], v[180:183], 0
    v_mfma_f32_16x16x32_bf16 v[148:151], v[160:163], v[152:155], 0
    s_waitcnt lgkmcnt(0)
    v_mfma_f32_32x32x16_bf16 v[20:35], v[168:171], v[184:187], v[20:35]
    s_waitcnt vmcnt(16)
    s_barrier
    ds_read_b64_tr_b16 v[160:161], v119 offset:8192
    ds_read_b64_tr_b16 v[162:163], v119 offset:9216
    ds_read_b128 v[176:179], v123 offset:0
    v_mfma_f32_32x32x16_bf16 v[36:51], v[168:171], v[188:191], v[36:51]
    ds_read_b64_tr_b16 v[164:165], v120 offset:8192
    ds_read_b64_tr_b16 v[166:167], v120 offset:9216
    ds_read_b128 v[180:183], v127 offset:0
    v_mfma_f32_32x32x16_bf16 v[52:67], v[172:175], v[184:187], v[52:67]
    s_add_u32 m0, s35, 49152
    s_add_u32 s32, s30, 458752
    buffer_load_dwordx4 v118, s[12:15], s32 offen lds
    v_mfma_f32_32x32x16_bf16 v[68:83], v[172:175], v[188:191], v[68:83]
    s_add_u32 m0, s35, 50176
    s_add_u32 s32, s30, 473088
    buffer_load_dwordx4 v118, s[12:15], s32 offen lds
    v_mfma_f32_16x16x32_bf16 v[148:151], v[168:171], v[152:155], v[148:151]
    s_waitcnt lgkmcnt(0)
    v_mfma_f32_32x32x16_bf16 v[20:35], v[160:163], v[176:179], v[20:35]
    ds_read_b64_tr_b16 v[168:169], v119 offset:12288
    ds_read_b64_tr_b16 v[170:171], v119 offset:13312
    ds_read_b128 v[184:187], v124 offset:0
    v_mfma_f32_32x32x16_bf16 v[36:51], v[160:163], v[180:183], v[36:51]
    ds_read_b64_tr_b16 v[172:173], v120 offset:12288
    ds_read_b64_tr_b16 v[174:175], v120 offset:13312
    ds_read_b128 v[188:191], v128 offset:0
    v_mfma_f32_32x32x16_bf16 v[52:67], v[164:167], v[176:179], v[52:67]
    v_mfma_f32_32x32x16_bf16 v[68:83], v[164:167], v[180:183], v[68:83]
    v_mfma_f32_16x16x32_bf16 v[148:151], v[160:163], v[152:155], v[148:151]
    s_waitcnt lgkmcnt(0)
    v_mfma_f32_32x32x16_bf16 v[20:35], v[168:171], v[184:187], v[20:35]
    s_waitcnt vmcnt(12)
    s_barrier
    ds_read_b64_tr_b16 v[160:161], v119 offset:16384
    ds_read_b64_tr_b16 v[162:163], v119 offset:17408
    ds_read_b128 v[176:179], v121 offset:16384
    v_mfma_f32_32x32x16_bf16 v[36:51], v[168:171], v[188:191], v[36:51]
    ds_read_b64_tr_b16 v[164:165], v120 offset:16384
    ds_read_b64_tr_b16 v[166:167], v120 offset:17408
    ds_read_b128 v[180:183], v125 offset:16384
    v_mfma_f32_32x32x16_bf16 v[52:67], v[172:175], v[184:187], v[52:67]
    s_add_u32 m0, s35, 57344
    s_add_u32 s32, s30, 573440
    buffer_load_dwordx4 v118, s[12:15], s32 offen lds
    v_mfma_f32_32x32x16_bf16 v[68:83], v[172:175], v[188:191], v[68:83]
    s_add_u32 m0, s35, 58368
    s_add_u32 s32, s30, 587776
    buffer_load_dwordx4 v118, s[12:15], s32 offen lds
    v_mfma_f32_16x16x32_bf16 v[148:151], v[168:171], v[152:155], v[148:151]
    s_waitcnt lgkmcnt(0)
    v_mfma_f32_32x32x16_bf16 v[20:35], v[160:163], v[176:179], v[20:35]
    ds_read_b64_tr_b16 v[168:169], v119 offset:20480
    ds_read_b64_tr_b16 v[170:171], v119 offset:21504
    ds_read_b128 v[184:187], v122 offset:16384
    v_mfma_f32_32x32x16_bf16 v[36:51], v[160:163], v[180:183], v[36:51]
    ds_read_b64_tr_b16 v[172:173], v120 offset:20480
    ds_read_b64_tr_b16 v[174:175], v120 offset:21504
    ds_read_b128 v[188:191], v126 offset:16384
    v_mfma_f32_32x32x16_bf16 v[52:67], v[164:167], v[176:179], v[52:67]
    s_add_u32 m0, s31, 0
    s_add_u32 s32, s29, 384
    buffer_load_dwordx4 v116, s[8:11], s32 offen lds
    v_mfma_f32_32x32x16_bf16 v[68:83], v[164:167], v[180:183], v[68:83]
    s_add_u32 m0, s31, 1024
    s_add_u32 s32, s29, 7552
    buffer_load_dwordx4 v117, s[8:11], s32 offen lds
    v_mfma_f32_16x16x32_bf16 v[148:151], v[160:163], v[152:155], v[148:151]
    s_add_u32 m0, s31, 2048
    s_add_u32 s32, s29, 14720
    buffer_load_dwordx4 v116, s[8:11], s32 offen lds
    s_add_u32 m0, s31, 3072
    s_add_u32 s32, s29, 21888
    buffer_load_dwordx4 v117, s[8:11], s32 offen lds
    s_waitcnt lgkmcnt(0)
    v_mfma_f32_32x32x16_bf16 v[20:35], v[168:171], v[184:187], v[20:35]
    s_waitcnt vmcnt(16)
    s_barrier
    ds_read_b64_tr_b16 v[160:161], v119 offset:24576
    ds_read_b64_tr_b16 v[162:163], v119 offset:25600
    ds_read_b128 v[176:179], v123 offset:16384
    v_mfma_f32_32x32x16_bf16 v[36:51], v[168:171], v[188:191], v[36:51]
    ds_read_b64_tr_b16 v[164:165], v120 offset:24576
    ds_read_b64_tr_b16 v[166:167], v120 offset:25600
    ds_read_b128 v[180:183], v127 offset:16384
    v_mfma_f32_32x32x16_bf16 v[52:67], v[172:175], v[184:187], v[52:67]
    s_add_u32 m0, s35, 65536
    s_add_u32 s32, s30, 688128
    buffer_load_dwordx4 v118, s[12:15], s32 offen lds
    v_mfma_f32_32x32x16_bf16 v[68:83], v[172:175], v[188:191], v[68:83]
    s_add_u32 m0, s35, 66560
    s_add_u32 s32, s30, 702464
    buffer_load_dwordx4 v118, s[12:15], s32 offen lds
    v_mfma_f32_16x16x32_bf16 v[148:151], v[168:171], v[152:155], v[148:151]
    s_waitcnt lgkmcnt(0)
    v_mfma_f32_32x32x16_bf16 v[20:35], v[160:163], v[176:179], v[20:35]
    ds_read_b64_tr_b16 v[168:169], v119 offset:28672
    ds_read_b64_tr_b16 v[170:171], v119 offset:29696
    ds_read_b128 v[184:187], v124 offset:16384
    v_mfma_f32_32x32x16_bf16 v[36:51], v[160:163], v[180:183], v[36:51]
    ds_read_b64_tr_b16 v[172:173], v120 offset:28672
    ds_read_b64_tr_b16 v[174:175], v120 offset:29696
    ds_read_b128 v[188:191], v128 offset:16384
    v_mfma_f32_32x32x16_bf16 v[52:67], v[164:167], v[176:179], v[52:67]
    v_mfma_f32_32x32x16_bf16 v[68:83], v[164:167], v[180:183], v[68:83]
    v_mfma_f32_16x16x32_bf16 v[148:151], v[160:163], v[152:155], v[148:151]
    s_waitcnt lgkmcnt(0)
    v_mfma_f32_32x32x16_bf16 v[20:35], v[168:171], v[184:187], v[20:35]
    s_waitcnt vmcnt(8)
    s_barrier
    ds_read_b64_tr_b16 v[160:161], v119 offset:0
    ds_read_b64_tr_b16 v[162:163], v119 offset:1024
    ds_read_b128 v[176:179], v121 offset:32768
    v_mfma_f32_32x32x16_bf16 v[36:51], v[168:171], v[188:191], v[36:51]
    ds_read_b64_tr_b16 v[164:165], v120 offset:0
    ds_read_b64_tr_b16 v[166:167], v120 offset:1024
    ds_read_b128 v[180:183], v125 offset:32768
    v_mfma_f32_32x32x16_bf16 v[52:67], v[172:175], v[184:187], v[52:67]
    s_add_u32 m0, s35, 73728
    s_add_u32 s32, s30, 802816
    buffer_load_dwordx4 v118, s[12:15], s32 offen lds
    v_mfma_f32_32x32x16_bf16 v[68:83], v[172:175], v[188:191], v[68:83]
    s_add_u32 m0, s35, 74752
    s_add_u32 s32, s30, 817152
    buffer_load_dwordx4 v118, s[12:15], s32 offen lds
    v_mfma_f32_16x16x32_bf16 v[148:151], v[168:171], v[152:155], v[148:151]
    s_waitcnt lgkmcnt(0)
    v_mfma_f32_32x32x16_bf16 v[20:35], v[160:163], v[176:179], v[20:35]
    ds_read_b64_tr_b16 v[168:169], v119 offset:4096
    ds_read_b64_tr_b16 v[170:171], v119 offset:5120
    ds_read_b128 v[184:187], v122 offset:32768
    v_mfma_f32_32x32x16_bf16 v[36:51], v[160:163], v[180:183], v[36:51]
    ds_read_b64_tr_b16 v[172:173], v120 offset:4096
    ds_read_b64_tr_b16 v[174:175], v120 offset:5120
    ds_read_b128 v[188:191], v126 offset:32768
    v_mfma_f32_32x32x16_bf16 v[52:67], v[164:167], v[176:179], v[52:67]
    s_add_u32 m0, s31, 16384
    s_add_u32 s32, s29, 512
    buffer_load_dwordx4 v116, s[8:11], s32 offen lds
    v_mfma_f32_32x32x16_bf16 v[68:83], v[164:167], v[180:183], v[68:83]
    s_add_u32 m0, s31, 17408
    s_add_u32 s32, s29, 7680
    buffer_load_dwordx4 v117, s[8:11], s32 offen lds
    v_mfma_f32_16x16x32_bf16 v[148:151], v[160:163], v[152:155], v[148:151]
    s_add_u32 m0, s31, 18432
    s_add_u32 s32, s29, 14848
    buffer_load_dwordx4 v116, s[8:11], s32 offen lds
    s_add_u32 m0, s31, 19456
    s_add_u32 s32, s29, 22016
    buffer_load_dwordx4 v117, s[8:11], s32 offen lds
    s_waitcnt lgkmcnt(0)
    v_mfma_f32_32x32x16_bf16 v[20:35], v[168:171], v[184:187], v[20:35]
    s_waitcnt vmcnt(12)
    s_barrier
    ds_read_b64_tr_b16 v[160:161], v119 offset:8192
    ds_read_b64_tr_b16 v[162:163], v119 offset:9216
    ds_read_b128 v[176:179], v123 offset:32768
    v_mfma_f32_32x32x16_bf16 v[36:51], v[168:171], v[188:191], v[36:51]
    ds_read_b64_tr_b16 v[164:165], v120 offset:8192
    ds_read_b64_tr_b16 v[166:167], v120 offset:9216
    ds_read_b128 v[180:183], v127 offset:32768
    v_mfma_f32_32x32x16_bf16 v[52:67], v[172:175], v[184:187], v[52:67]
    s_add_u32 m0, s35, 49152
    s_add_u32 s32, s30, 917504
    buffer_load_dwordx4 v118, s[12:15], s32 offen lds
    v_mfma_f32_32x32x16_bf16 v[68:83], v[172:175], v[188:191], v[68:83]
    s_add_u32 m0, s35, 50176
    s_add_u32 s32, s30, 931840
    buffer_load_dwordx4 v118, s[12:15], s32 offen lds
    v_mfma_f32_16x16x32_bf16 v[148:151], v[168:171], v[152:155], v[148:151]
    s_waitcnt lgkmcnt(0)
    v_mfma_f32_32x32x16_bf16 v[20:35], v[160:163], v[176:179], v[20:35]
    ds_read_b64_tr_b16 v[168:169], v119 offset:12288
    ds_read_b64_tr_b16 v[170:171], v119 offset:13312
    ds_read_b128 v[184:187], v124 offset:32768
    v_mfma_f32_32x32x16_bf16 v[36:51], v[160:163], v[180:183], v[36:51]
    ds_read_b64_tr_b16 v[172:173], v120 offset:12288
    ds_read_b64_tr_b16 v[174:175], v120 offset:13312
    ds_read_b128 v[188:191], v128 offset:32768
    v_mfma_f32_32x32x16_bf16 v[52:67], v[164:167], v[176:179], v[52:67]
    v_mfma_f32_32x32x16_bf16 v[68:83], v[164:167], v[180:183], v[68:83]
    v_mfma_f32_16x16x32_bf16 v[148:151], v[160:163], v[152:155], v[148:151]
    s_waitcnt lgkmcnt(0)
    v_mfma_f32_32x32x16_bf16 v[20:35], v[168:171], v[184:187], v[20:35]
    s_waitcnt vmcnt(8)
    s_barrier
    ds_read_b64_tr_b16 v[160:161], v119 offset:16384
    ds_read_b64_tr_b16 v[162:163], v119 offset:17408
    ds_read_b128 v[176:179], v121 offset:0
    v_mfma_f32_32x32x16_bf16 v[36:51], v[168:171], v[188:191], v[36:51]
    ds_read_b64_tr_b16 v[164:165], v120 offset:16384
    ds_read_b64_tr_b16 v[166:167], v120 offset:17408
    ds_read_b128 v[180:183], v125 offset:0
    v_mfma_f32_32x32x16_bf16 v[52:67], v[172:175], v[184:187], v[52:67]
    s_add_u32 m0, s35, 57344
    s_add_u32 s32, s30, 1032192
    buffer_load_dwordx4 v118, s[12:15], s32 offen lds
    v_mfma_f32_32x32x16_bf16 v[68:83], v[172:175], v[188:191], v[68:83]
    s_add_u32 m0, s35, 58368
    s_add_u32 s32, s30, 1046528
    buffer_load_dwordx4 v118, s[12:15], s32 offen lds
    v_mfma_f32_16x16x32_bf16 v[148:151], v[168:171], v[152:155], v[148:151]
    s_waitcnt lgkmcnt(0)
    v_mfma_f32_32x32x16_bf16 v[20:35], v[160:163], v[176:179], v[20:35]
    ds_read_b64_tr_b16 v[168:169], v119 offset:20480
    ds_read_b64_tr_b16 v[170:171], v119 offset:21504
    ds_read_b128 v[184:187], v122 offset:0
    v_mfma_f32_32x32x16_bf16 v[36:51], v[160:163], v[180:183], v[36:51]
    ds_read_b64_tr_b16 v[172:173], v120 offset:20480
    ds_read_b64_tr_b16 v[174:175], v120 offset:21504
    ds_read_b128 v[188:191], v126 offset:0
    v_mfma_f32_32x32x16_bf16 v[52:67], v[164:167], v[176:179], v[52:67]
    s_add_u32 m0, s31, 32768
    s_add_u32 s32, s29, 640
    buffer_load_dwordx4 v116, s[8:11], s32 offen lds
    v_mfma_f32_32x32x16_bf16 v[68:83], v[164:167], v[180:183], v[68:83]
    s_add_u32 m0, s31, 33792
    s_add_u32 s32, s29, 7808
    buffer_load_dwordx4 v117, s[8:11], s32 offen lds
    v_mfma_f32_16x16x32_bf16 v[148:151], v[160:163], v[152:155], v[148:151]
    s_add_u32 m0, s31, 34816
    s_add_u32 s32, s29, 14976
    buffer_load_dwordx4 v116, s[8:11], s32 offen lds
    s_add_u32 m0, s31, 35840
    s_add_u32 s32, s29, 22144
    buffer_load_dwordx4 v117, s[8:11], s32 offen lds
    s_and_b32 s32, s24, 3
    s_lshl_b32 s32, s32, 2
    s_add_u32 s32, s32, s26
    s_mul_i32 s32, s32, 100352
    s_lshl_b32 s33, s39, 7
    s_add_u32 s32, s32, s33
    v_mul_u32_u24 v4, 896, v3
    buffer_load_dword v17, v4, s[40:43], s32 offen
    s_add_u32 s32, s32, 43008
    buffer_load_dword v18, v4, s[40:43], s32 offen
    s_waitcnt lgkmcnt(0)
    v_mfma_f32_32x32x16_bf16 v[20:35], v[168:171], v[184:187], v[20:35]
    s_waitcnt vmcnt(14)
    s_barrier
    ds_read_b64_tr_b16 v[160:161], v119 offset:24576
    ds_read_b64_tr_b16 v[162:163], v119 offset:25600
    ds_read_b128 v[176:179], v123 offset:0
    v_mfma_f32_32x32x16_bf16 v[36:51], v[168:171], v[188:191], v[36:51]
    ds_read_b64_tr_b16 v[164:165], v120 offset:24576
    ds_read_b64_tr_b16 v[166:167], v120 offset:25600
    ds_read_b128 v[180:183], v127 offset:0
    v_mfma_f32_32x32x16_bf16 v[52:67], v[172:175], v[184:187], v[52:67]
    s_add_u32 m0, s35, 65536
    s_add_u32 s32, s30, 1146880
    buffer_load_dwordx4 v118, s[12:15], s32 offen lds
    v_mfma_f32_32x32x16_bf16 v[68:83], v[172:175], v[188:191], v[68:83]
    s_add_u32 m0, s35, 66560
    s_add_u32 s32, s30, 1161216
    buffer_load_dwordx4 v118, s[12:15], s32 offen lds
    v_mfma_f32_16x16x32_bf16 v[148:151], v[168:171], v[152:155], v[148:151]
    s_waitcnt lgkmcnt(0)
    v_mfma_f32_32x32x16_bf16 v[20:35], v[160:163], v[176:179], v[20:35]
    ds_read_b64_tr_b16 v[168:169], v119 offset:28672
    ds_read_b64_tr_b16 v[170:171], v119 offset:29696
    ds_read_b128 v[184:187], v124 offset:0
    v_mfma_f32_32x32x16_bf16 v[36:51], v[160:163], v[180:183], v[36:51]
    ds_read_b64_tr_b16 v[172:173], v120 offset:28672
    ds_read_b64_tr_b16 v[174:175], v120 offset:29696
    ds_read_b128 v[188:191], v128 offset:0
    v_mfma_f32_32x32x16_bf16 v[52:67], v[164:167], v[176:179], v[52:67]
    v_mfma_f32_32x32x16_bf16 v[68:83], v[164:167], v[180:183], v[68:83]
    v_mfma_f32_16x16x32_bf16 v[148:151], v[160:163], v[152:155], v[148:151]
    s_waitcnt lgkmcnt(0)
    v_mfma_f32_32x32x16_bf16 v[20:35], v[168:171], v[184:187], v[20:35]
    s_waitcnt vmcnt(10)
    s_barrier
    ds_read_b64_tr_b16 v[160:161], v119 offset:0
    ds_read_b64_tr_b16 v[162:163], v119 offset:1024
    ds_read_b128 v[176:179], v121 offset:16384
    v_mfma_f32_32x32x16_bf16 v[36:51], v[168:171], v[188:191], v[36:51]
    ds_read_b64_tr_b16 v[164:165], v120 offset:0
    ds_read_b64_tr_b16 v[166:167], v120 offset:1024
    ds_read_b128 v[180:183], v125 offset:16384
    v_mfma_f32_32x32x16_bf16 v[52:67], v[172:175], v[184:187], v[52:67]
    s_add_u32 m0, s35, 73728
    s_add_u32 s32, s30, 1261568
    buffer_load_dwordx4 v118, s[12:15], s32 offen lds
    v_mfma_f32_32x32x16_bf16 v[68:83], v[172:175], v[188:191], v[68:83]
    s_add_u32 m0, s35, 74752
    s_add_u32 s32, s30, 1275904
    buffer_load_dwordx4 v118, s[12:15], s32 offen lds
    v_mfma_f32_16x16x32_bf16 v[148:151], v[168:171], v[152:155], v[148:151]
    s_waitcnt lgkmcnt(0)
    v_mfma_f32_32x32x16_bf16 v[20:35], v[160:163], v[176:179], v[20:35]
    ds_read_b64_tr_b16 v[168:169], v119 offset:4096
    ds_read_b64_tr_b16 v[170:171], v119 offset:5120
    ds_read_b128 v[184:187], v122 offset:16384
    v_mfma_f32_32x32x16_bf16 v[36:51], v[160:163], v[180:183], v[36:51]
    ds_read_b64_tr_b16 v[172:173], v120 offset:4096
    ds_read_b64_tr_b16 v[174:175], v120 offset:5120
    ds_read_b128 v[188:191], v126 offset:16384
    v_mfma_f32_32x32x16_bf16 v[52:67], v[164:167], v[176:179], v[52:67]
    s_add_u32 m0, s31, 0
    s_add_u32 s32, s29, 768
    buffer_load_dwordx4 v116, s[8:11], s32 offen lds
    v_mfma_f32_32x32x16_bf16 v[68:83], v[164:167], v[180:183], v[68:83]
    s_add_u32 m0, s31, 1024
    s_add_u32 s32, s29, 7936
    buffer_load_dwordx4 v117, s[8:11], s32 offen lds
    v_mfma_f32_16x16x32_bf16 v[148:151], v[160:163], v[152:155], v[148:151]
    s_add_u32 m0, s31, 2048
    s_add_u32 s32, s29, 15104
    buffer_load_dwordx4 v116, s[8:11], s32 offen lds
    s_add_u32 m0, s31, 3072
    s_add_u32 s32, s29, 22272
    buffer_load_dwordx4 v117, s[8:11], s32 offen lds
    s_waitcnt lgkmcnt(0)
    v_mfma_f32_32x32x16_bf16 v[20:35], v[168:171], v[184:187], v[20:35]
    s_waitcnt vmcnt(14)
    s_barrier
    ds_read_b64_tr_b16 v[160:161], v119 offset:8192
    ds_read_b64_tr_b16 v[162:163], v119 offset:9216
    ds_read_b128 v[176:179], v123 offset:16384
    v_mfma_f32_32x32x16_bf16 v[36:51], v[168:171], v[188:191], v[36:51]
    ds_read_b64_tr_b16 v[164:165], v120 offset:8192
    ds_read_b64_tr_b16 v[166:167], v120 offset:9216
    ds_read_b128 v[180:183], v127 offset:16384
    v_mfma_f32_32x32x16_bf16 v[52:67], v[172:175], v[184:187], v[52:67]
    s_add_u32 m0, s35, 49152
    s_add_u32 s32, s30, 1376256
    buffer_load_dwordx4 v118, s[12:15], s32 offen lds
    v_mfma_f32_32x32x16_bf16 v[68:83], v[172:175], v[188:191], v[68:83]
    s_add_u32 m0, s35, 50176
    s_add_u32 s32, s30, 1390592
    buffer_load_dwordx4 v118, s[12:15], s32 offen lds
    v_mfma_f32_16x16x32_bf16 v[148:151], v[168:171], v[152:155], v[148:151]
    s_waitcnt lgkmcnt(0)
    v_mfma_f32_32x32x16_bf16 v[20:35], v[160:163], v[176:179], v[20:35]
    ds_read_b64_tr_b16 v[168:169], v119 offset:12288
    ds_read_b64_tr_b16 v[170:171], v119 offset:13312
    ds_read_b128 v[184:187], v124 offset:16384
    v_mfma_f32_32x32x16_bf16 v[36:51], v[160:163], v[180:183], v[36:51]
    ds_read_b64_tr_b16 v[172:173], v120 offset:12288
    ds_read_b64_tr_b16 v[174:175], v120 offset:13312
    ds_read_b128 v[188:191], v128 offset:16384
    v_mfma_f32_32x32x16_bf16 v[52:67], v[164:167], v[176:179], v[52:67]
    v_mfma_f32_32x32x16_bf16 v[68:83], v[164:167], v[180:183], v[68:83]
    v_mfma_f32_16x16x32_bf16 v[148:151], v[160:163], v[152:155], v[148:151]
    s_waitcnt lgkmcnt(0)
    v_mfma_f32_32x32x16_bf16 v[20:35], v[168:171], v[184:187], v[20:35]
    s_waitcnt vmcnt(8)
    s_barrier
    ds_read_b64_tr_b16 v[160:161], v119 offset:16384
    ds_read_b64_tr_b16 v[162:163], v119 offset:17408
    ds_read_b128 v[176:179], v121 offset:32768
    v_mfma_f32_32x32x16_bf16 v[36:51], v[168:171], v[188:191], v[36:51]
    ds_read_b64_tr_b16 v[164:165], v120 offset:16384
    ds_read_b64_tr_b16 v[166:167], v120 offset:17408
    ds_read_b128 v[180:183], v125 offset:32768
    v_mfma_f32_32x32x16_bf16 v[52:67], v[172:175], v[184:187], v[52:67]
    s_add_u32 m0, s35, 57344
    s_add_u32 s32, s30, 1490944
    buffer_load_dwordx4 v118, s[12:15], s32 offen lds
    v_mfma_f32_32x32x16_bf16 v[68:83], v[172:175], v[188:191], v[68:83]
    s_add_u32 m0, s35, 58368
    s_add_u32 s32, s30, 1505280
    buffer_load_dwordx4 v118, s[12:15], s32 offen lds
    v_mfma_f32_16x16x32_bf16 v[148:151], v[168:171], v[152:155], v[148:151]
    s_waitcnt lgkmcnt(0)
    v_mfma_f32_32x32x16_bf16 v[20:35], v[160:163], v[176:179], v[20:35]
    ds_read_b64_tr_b16 v[168:169], v119 offset:20480
    ds_read_b64_tr_b16 v[170:171], v119 offset:21504
    ds_read_b128 v[184:187], v122 offset:32768
    v_mfma_f32_32x32x16_bf16 v[36:51], v[160:163], v[180:183], v[36:51]
    ds_read_b64_tr_b16 v[172:173], v120 offset:20480
    ds_read_b64_tr_b16 v[174:175], v120 offset:21504
    ds_read_b128 v[188:191], v126 offset:32768
    v_mfma_f32_32x32x16_bf16 v[52:67], v[164:167], v[176:179], v[52:67]
    v_mfma_f32_32x32x16_bf16 v[68:83], v[164:167], v[180:183], v[68:83]
    v_mfma_f32_16x16x32_bf16 v[148:151], v[160:163], v[152:155], v[148:151]
    s_waitcnt lgkmcnt(0)
    v_mfma_f32_32x32x16_bf16 v[20:35], v[168:171], v[184:187], v[20:35]
    s_waitcnt vmcnt(8)
    s_barrier
    ds_read_b64_tr_b16 v[160:161], v119 offset:24576
    ds_read_b64_tr_b16 v[162:163], v119 offset:25600
    ds_read_b128 v[176:179], v123 offset:32768
    v_mfma_f32_32x32x16_bf16 v[36:51], v[168:171], v[188:191], v[36:51]
    ds_read_b64_tr_b16 v[164:165], v120 offset:24576
    ds_read_b64_tr_b16 v[166:167], v120 offset:25600
    ds_read_b128 v[180:183], v127 offset:32768
    v_mfma_f32_32x32x16_bf16 v[52:67], v[172:175], v[184:187], v[52:67]
    v_mfma_f32_32x32x16_bf16 v[68:83], v[172:175], v[188:191], v[68:83]
    v_mfma_f32_16x16x32_bf16 v[148:151], v[168:171], v[152:155], v[148:151]
    s_waitcnt lgkmcnt(0)
    v_mfma_f32_32x32x16_bf16 v[20:35], v[160:163], v[176:179], v[20:35]
    ds_read_b64_tr_b16 v[168:169], v119 offset:28672
    ds_read_b64_tr_b16 v[170:171], v119 offset:29696
    ds_read_b128 v[184:187], v124 offset:32768
    v_mfma_f32_32x32x16_bf16 v[36:51], v[160:163], v[180:183], v[36:51]
    ds_read_b64_tr_b16 v[172:173], v120 offset:28672
    ds_read_b64_tr_b16 v[174:175], v120 offset:29696
    ds_read_b128 v[188:191], v128 offset:32768
    v_mfma_f32_32x32x16_bf16 v[52:67], v[164:167], v[176:179], v[52:67]
    s_mov_b64 exec, 0x1
    global_load_dword v13, v12, s[56:57] sc1
    s_mov_b64 exec, -1
    v_mfma_f32_32x32x16_bf16 v[68:83], v[164:167], v[180:183], v[68:83]
    v_mfma_f32_16x16x32_bf16 v[148:151], v[160:163], v[152:155], v[148:151]
    s_waitcnt lgkmcnt(0)
    v_mfma_f32_32x32x16_bf16 v[20:35], v[168:171], v[184:187], v[20:35]
    s_waitcnt vmcnt(3)
    s_barrier
    ds_read_b64_tr_b16 v[160:161], v119 offset:0
    ds_read_b64_tr_b16 v[162:163], v119 offset:1024
    ds_read_b128 v[176:179], v121 offset:0
    v_mfma_f32_32x32x16_bf16 v[36:51], v[168:171], v[188:191], v[36:51]
    ds_read_b64_tr_b16 v[164:165], v120 offset:0
    ds_read_b64_tr_b16 v[166:167], v120 offset:1024
    ds_read_b128 v[180:183], v125 offset:0
    v_mfma_f32_32x32x16_bf16 v[52:67], v[172:175], v[184:187], v[52:67]
    v_mfma_f32_32x32x16_bf16 v[68:83], v[172:175], v[188:191], v[68:83]
    v_mfma_f32_16x16x32_bf16 v[148:151], v[168:171], v[152:155], v[148:151]
    s_waitcnt lgkmcnt(0)
    v_mfma_f32_32x32x16_bf16 v[20:35], v[160:163], v[176:179], v[20:35]
    ds_read_b64_tr_b16 v[168:169], v119 offset:4096
    ds_read_b64_tr_b16 v[170:171], v119 offset:5120
    ds_read_b128 v[184:187], v122 offset:0
    v_mfma_f32_32x32x16_bf16 v[36:51], v[160:163], v[180:183], v[36:51]
    ds_read_b64_tr_b16 v[172:173], v120 offset:4096
    ds_read_b64_tr_b16 v[174:175], v120 offset:5120
    ds_read_b128 v[188:191], v126 offset:0
    v_mfma_f32_32x32x16_bf16 v[52:67], v[164:167], v[176:179], v[52:67]
    v_mfma_f32_32x32x16_bf16 v[68:83], v[164:167], v[180:183], v[68:83]
    v_mfma_f32_16x16x32_bf16 v[148:151], v[160:163], v[152:155], v[148:151]
    s_waitcnt lgkmcnt(0)
    v_mfma_f32_32x32x16_bf16 v[20:35], v[168:171], v[184:187], v[20:35]
    s_waitcnt vmcnt(1)
    s_barrier
    ds_read_b64_tr_b16 v[160:161], v119 offset:8192
    ds_read_b64_tr_b16 v[162:163], v119 offset:9216
    ds_read_b128 v[176:179], v123 offset:0
    v_mfma_f32_32x32x16_bf16 v[36:51], v[168:171], v[188:191], v[36:51]
    ds_read_b64_tr_b16 v[164:165], v120 offset:8192
    ds_read_b64_tr_b16 v[166:167], v120 offset:9216
    ds_read_b128 v[180:183], v127 offset:0
    v_mfma_f32_32x32x16_bf16 v[52:67], v[172:175], v[184:187], v[52:67]
    v_mfma_f32_32x32x16_bf16 v[68:83], v[172:175], v[188:191], v[68:83]
    v_mfma_f32_16x16x32_bf16 v[148:151], v[168:171], v[152:155], v[148:151]
    s_waitcnt lgkmcnt(0)
    v_mfma_f32_32x32x16_bf16 v[20:35], v[160:163], v[176:179], v[20:35]
    ds_read_b64_tr_b16 v[168:169], v119 offset:12288
    ds_read_b64_tr_b16 v[170:171], v119 offset:13312
    ds_read_b128 v[184:187], v124 offset:0
    v_mfma_f32_32x32x16_bf16 v[36:51], v[160:163], v[180:183], v[36:51]
    ds_read_b64_tr_b16 v[172:173], v120 offset:12288
    ds_read_b64_tr_b16 v[174:175], v120 offset:13312
    ds_read_b128 v[188:191], v128 offset:0
    v_mfma_f32_32x32x16_bf16 v[52:67], v[164:167], v[176:179], v[52:67]
    s_waitcnt vmcnt(0)
    s_mov_b64 exec, 0x1
    v_cmp_le_u32 vcc, 1, v13
    s_nop 0
    s_cmp_eq_u64 vcc, exec
    s_mov_b64 exec, -1
    s_cselect_b32 s37, 1, 0
    v_and_b32 v5, 31, v3
    v_lshlrev_b32 v5, 3, v5
    s_xor_b32 s32, s27, 0
    s_lshl_b32 s33, s28, 1
    s_add_u32 s32, s32, s33
    s_lshl_b32 s33, s24, 2
    s_add_u32 s32, s32, s33
    s_lshl_b32 s33, s32, 8
    s_add_u32 s33, s33, 12845056
    buffer_load_dwordx2 v[112:113], v5, s[16:19], s33 offen sc1
    s_lshl_b32 s33, s32, 10
    s_add_u32 s33, s33, 12918784
    buffer_load_dwordx4 v[140:143], v10, s[16:19], s33 offen sc1
    s_xor_b32 s32, s27, 1
    s_lshl_b32 s33, s28, 1
    s_add_u32 s32, s32, s33
    s_lshl_b32 s33, s24, 2
    s_add_u32 s32, s32, s33
    s_lshl_b32 s33, s32, 8
    s_add_u32 s33, s33, 12845056
    buffer_load_dwordx2 v[114:115], v5, s[16:19], s33 offen sc1
    s_lshl_b32 s33, s32, 10
    s_add_u32 s33, s33, 12918784
    buffer_load_dwordx4 v[144:147], v10, s[16:19], s33 offen sc1
    v_mfma_f32_32x32x16_bf16 v[68:83], v[164:167], v[180:183], v[68:83]
    v_mfma_f32_16x16x32_bf16 v[148:151], v[160:163], v[152:155], v[148:151]
    s_waitcnt lgkmcnt(0)
    v_mfma_f32_32x32x16_bf16 v[20:35], v[168:171], v[184:187], v[20:35]
    s_barrier
    v_mfma_f32_32x32x16_bf16 v[36:51], v[168:171], v[188:191], v[36:51]
    v_mfma_f32_32x32x16_bf16 v[52:67], v[172:175], v[184:187], v[52:67]
    v_mfma_f32_32x32x16_bf16 v[68:83], v[172:175], v[188:191], v[68:83]
    v_mfma_f32_16x16x32_bf16 v[148:151], v[168:171], v[152:155], v[148:151]
    s_lshl_b32 s32, s27, 1
    s_add_u32 s32, s32, s28
    s_lshl_b32 s32, s32, 7
    s_add_u32 s32, s32, 79872
    v_and_b32 v5, 15, v3
    v_lshrrev_b32 v6, 4, v3
    v_lshlrev_b32 v6, 4, v6
    v_lshl_add_u32 v6, v5, 6, v6
    v_add_u32 v6, s32, v6
    v_cmp_gt_u32 vcc, 2, v5
    v_mov_b32 v7, 80384
    v_lshl_add_u32 v7, v3, 4, v7
    v_cndmask_b32 v6, v7, v6, vcc
    ds_write_b128 v6, v[148:151]
    s_waitcnt lgkmcnt(0)
    s_barrier
    v_and_b32 v5, 31, v3
    v_lshlrev_b32 v5, 2, v5
    s_xor_b32 s32, s28, 0
    s_lshl_b32 s33, s27, 1
    s_add_u32 s32, s32, s33
    s_lshl_b32 s32, s32, 7
    s_add_u32 s32, s32, 79872
    v_add_u32 v6, s32, v5
    ds_read_b32 v148, v6
    s_xor_b32 s32, s28, 1
    s_lshl_b32 s33, s27, 1
    s_add_u32 s32, s32, s33
    s_lshl_b32 s32, s32, 7
    s_add_u32 s32, s32, 79872
    v_add_u32 v6, s32, v5
    ds_read_b32 v149, v6
    v_cmp_gt_u32 vcc, 32, v3
    s_waitcnt lgkmcnt(0)
    s_barrier
    v_cvt_pk_bf16_f32 v5, v148, v148
    v_and_b32 v5, 0xffff0000, v5
    v_sub_f32 v5, v148, v5
    v_cvt_pk_bf16_f32 v5, v148, v5
    v_cndmask_b32 v132, 0, v5, vcc
    v_cndmask_b32 v133, 0, v156, vcc
    v_mov_b32 v134, 0
    v_mov_b32 v135, 0
    v_cvt_pk_bf16_f32 v5, v149, v149
    v_and_b32 v5, 0xffff0000, v5
    v_sub_f32 v5, v149, v5
    v_cvt_pk_bf16_f32 v5, v149, v5
    v_cndmask_b32 v136, 0, v5, vcc
    v_cndmask_b32 v137, 0, v157, vcc
    v_mov_b32 v138, 0
    v_mov_b32 v139, 0
    s_cmp_eq_u32 s37, 1
    s_cbranch_scc1 L_st_ok_12
    s_mov_b32 s88, 0x40000
L_spin_13:
    s_mov_b64 exec, 0x1
    global_load_dword v13, v12, s[56:57] sc1
    s_mov_b64 exec, -1
    s_waitcnt vmcnt(0)
    s_mov_b64 exec, 0x1
    v_cmp_le_u32 vcc, 1, v13
    s_nop 0
    s_cmp_eq_u64 vcc, exec
    s_mov_b64 exec, -1
    s_cbranch_scc1 L_spun_14
    s_sleep 8
    s_sub_u32 s88, s88, 1
    s_cmp_lg_u32 s88, 0
    s_cbranch_scc1 L_spin_13
L_spun_14:
    v_and_b32 v5, 31, v3
    v_lshlrev_b32 v5, 3, v5
    s_xor_b32 s32, s27, 0
    s_lshl_b32 s33, s28, 1
    s_add_u32 s32, s32, s33
    s_lshl_b32 s33, s24, 2
    s_add_u32 s32, s32, s33
    s_lshl_b32 s33, s32, 8
    s_add_u32 s33, s33, 12845056
    buffer_load_dwordx2 v[112:113], v5, s[16:19], s33 offen sc1
    s_lshl_b32 s33, s32, 10
    s_add_u32 s33, s33, 12918784
    buffer_load_dwordx4 v[140:143], v10, s[16:19], s33 offen sc1
    s_xor_b32 s32, s27, 1
    s_lshl_b32 s33, s28, 1
    s_add_u32 s32, s32, s33
    s_lshl_b32 s33, s24, 2
    s_add_u32 s32, s32, s33
    s_lshl_b32 s33, s32, 8
    s_add_u32 s33, s33, 12845056
    buffer_load_dwordx2 v[114:115], v5, s[16:19], s33 offen sc1
    s_lshl_b32 s33, s32, 10
    s_add_u32 s33, s33, 12918784
    buffer_load_dwordx4 v[144:147], v10, s[16:19], s33 offen sc1
    s_waitcnt vmcnt(0)
L_st_ok_12:
    s_waitcnt vmcnt(0)
    v_mfma_f32_32x32x16_bf16 v[20:35], v[132:135], v[140:143], v[20:35]
    v_mfma_f32_32x32x16_bf16 v[36:51], v[132:135], v[144:147], v[36:51]
    v_mfma_f32_32x32x16_bf16 v[52:67], v[136:139], v[140:143], v[52:67]
    v_mfma_f32_32x32x16_bf16 v[68:83], v[136:139], v[144:147], v[68:83]
    v_mov_b32 v108, 0xc0135761
    v_mov_b32 v110, 0xbdd2d3e8
    v_mov_b32 v112, v113
    v_mov_b32 v109, 0xc0135761
    v_mov_b32 v111, 0xbdd2d3e8
    v_mov_b32 v114, v115
    s_xor_b32 s32, s28, 0
    s_lshl_b32 s33, s27, 1
    s_add_u32 s34, s32, s33
    s_xor_b32 s32, s27, 0
    s_lshl_b32 s33, s28, 1
    s_add_u32 s32, s32, s33
    s_lshl_b32 s33, s24, 2
    s_add_u32 s32, s32, s33
    s_mul_i32 s32, s32, 112
    s_lshl_b32 s33, s25, 3
    s_add_u32 s32, s32, s33
    s_lshl_b32 s33, s34, 1
    s_add_u32 s32, s32, s33
    s_lshl_b32 s36, s32, 10
    v_pk_mul_f32 v[92:93], v[20:21], v[112:113]
    v_pk_mul_f32 v[94:95], v[22:23], v[112:113]
    v_pk_mul_f32 v[96:97], v[24:25], v[112:113]
    v_pk_mul_f32 v[98:99], v[26:27], v[112:113]
    v_pk_mul_f32 v[84:85], v[92:93], v[92:93]
    v_pk_mul_f32 v[86:87], v[94:95], v[94:95]
    v_pk_mul_f32 v[88:89], v[96:97], v[96:97]
    v_pk_mul_f32 v[90:91], v[98:99], v[98:99]
    v_pk_fma_f32 v[84:85], v[84:85], v[110:111], v[108:109]
    v_pk_fma_f32 v[86:87], v[86:87], v[110:111], v[108:109]
    v_pk_fma_f32 v[88:89], v[88:89], v[110:111], v[108:109]
    v_pk_fma_f32 v[90:91], v[90:91], v[110:111], v[108:109]
    v_pk_mul_f32 v[84:85], v[92:93], v[84:85]
    v_pk_mul_f32 v[86:87], v[94:95], v[86:87]
    v_pk_mul_f32 v[88:89], v[96:97], v[88:89]
    v_pk_mul_f32 v[90:91], v[98:99], v[90:91]
    v_exp_f32 v84, v84
    v_exp_f32 v85, v85
    v_exp_f32 v86, v86
    v_exp_f32 v87, v87
    v_exp_f32 v88, v88
    v_exp_f32 v89, v89
    v_exp_f32 v90, v90
    v_exp_f32 v91, v91
    v_pk_add_f32 v[84:85], v[84:85], 1.0 op_sel_hi:[1,0]
    v_pk_add_f32 v[86:87], v[86:87], 1.0 op_sel_hi:[1,0]
    v_pk_add_f32 v[88:89], v[88:89], 1.0 op_sel_hi:[1,0]
    v_pk_add_f32 v[90:91], v[90:91], 1.0 op_sel_hi:[1,0]
    v_rcp_f32 v84, v84
    v_rcp_f32 v85, v85
    v_rcp_f32 v86, v86
    v_rcp_f32 v87, v87
    v_rcp_f32 v88, v88
    v_rcp_f32 v89, v89
    v_rcp_f32 v90, v90
    v_rcp_f32 v91, v91
    v_pk_mul_f32 v[84:85], v[92:93], v[84:85]
    v_pk_mul_f32 v[86:87], v[94:95], v[86:87]
    v_pk_mul_f32 v[88:89], v[96:97], v[88:89]
    v_pk_mul_f32 v[90:91], v[98:99], v[90:91]
    v_cvt_pk_bf16_f32 v100, v84, v85
    v_cvt_pk_bf16_f32 v101, v86, v87
    v_cvt_pk_bf16_f32 v102, v88, v89
    v_cvt_pk_bf16_f32 v103, v90, v91
    buffer_store_dwordx4 v[100:103], v10, s[16:19], s36 offen offset:0 sc1
    s_add_u32 m0, s22, 0
    s_add_u32 s32, s21, 0
    buffer_load_dwordx4 v11, s[40:43], s32 offen lds
    s_add_u32 m0, s22, 1024
    s_add_u32 s32, s21, 7168
    buffer_load_dwordx4 v11, s[40:43], s32 offen lds
    s_add_u32 m0, s22, 2048
    s_add_u32 s32, s21, 14336
    buffer_load_dwordx4 v11, s[40:43], s32 offen lds
    s_add_u32 m0, s22, 3072
    s_add_u32 s32, s21, 21504
    buffer_load_dwordx4 v11, s[40:43], s32 offen lds
    v_pk_mul_f32 v[92:93], v[28:29], v[112:113]
    v_pk_mul_f32 v[94:95], v[30:31], v[112:113]
    v_pk_mul_f32 v[96:97], v[32:33], v[112:113]
    v_pk_mul_f32 v[98:99], v[34:35], v[112:113]
    v_pk_mul_f32 v[84:85], v[92:93], v[92:93]
    v_pk_mul_f32 v[86:87], v[94:95], v[94:95]
    v_pk_mul_f32 v[88:89], v[96:97], v[96:97]
    v_pk_mul_f32 v[90:91], v[98:99], v[98:99]
    v_pk_fma_f32 v[84:85], v[84:85], v[110:111], v[108:109]
    v_pk_fma_f32 v[86:87], v[86:87], v[110:111], v[108:109]
    v_pk_fma_f32 v[88:89], v[88:89], v[110:111], v[108:109]
    v_pk_fma_f32 v[90:91], v[90:91], v[110:111], v[108:109]
    v_pk_mul_f32 v[84:85], v[92:93], v[84:85]
    v_pk_mul_f32 v[86:87], v[94:95], v[86:87]
    v_pk_mul_f32 v[88:89], v[96:97], v[88:89]
    v_pk_mul_f32 v[90:91], v[98:99], v[90:91]
    v_exp_f32 v84, v84
    v_exp_f32 v85, v85
    v_exp_f32 v86, v86
    v_exp_f32 v87, v87
    v_exp_f32 v88, v88
    v_exp_f32 v89, v89
    v_exp_f32 v90, v90
    v_exp_f32 v91, v91
    v_pk_add_f32 v[84:85], v[84:85], 1.0 op_sel_hi:[1,0]
    v_pk_add_f32 v[86:87], v[86:87], 1.0 op_sel_hi:[1,0]
    v_pk_add_f32 v[88:89], v[88:89], 1.0 op_sel_hi:[1,0]
    v_pk_add_f32 v[90:91], v[90:91], 1.0 op_sel_hi:[1,0]
    v_rcp_f32 v84, v84
    v_rcp_f32 v85, v85
    v_rcp_f32 v86, v86
    v_rcp_f32 v87, v87
    v_rcp_f32 v88, v88
    v_rcp_f32 v89, v89
    v_rcp_f32 v90, v90
    v_rcp_f32 v91, v91
    v_pk_mul_f32 v[84:85], v[92:93], v[84:85]
    v_pk_mul_f32 v[86:87], v[94:95], v[86:87]
    v_pk_mul_f32 v[88:89], v[96:97], v[88:89]
    v_pk_mul_f32 v[90:91], v[98:99], v[90:91]
    v_cvt_pk_bf16_f32 v104, v84, v85
    v_cvt_pk_bf16_f32 v105, v86, v87
    v_cvt_pk_bf16_f32 v106, v88, v89
    v_cvt_pk_bf16_f32 v107, v90, v91
    buffer_store_dwordx4 v[104:107], v10, s[16:19], s36 offen offset:1024 sc1
    s_add_u32 m0, s22, 4096
    s_add_u32 s32, s21, 28672
    buffer_load_dwordx4 v11, s[40:43], s32 offen lds
    s_add_u32 m0, s22, 5120
    s_add_u32 s32, s21, 35840
    buffer_load_dwordx4 v11, s[40:43], s32 offen lds
    s_add_u32 m0, s22, 6144
    s_add_u32 s32, s21, 43008
    buffer_load_dwordx4 v11, s[40:43], s32 offen lds
    s_add_u32 m0, s22, 7168
    s_add_u32 s32, s21, 50176
    buffer_load_dwordx4 v11, s[40:43], s32 offen lds
    s_xor_b32 s32, s27, 1
    s_lshl_b32 s33, s28, 1
    s_add_u32 s32, s32, s33
    s_lshl_b32 s33, s24, 2
    s_add_u32 s32, s32, s33
    s_mul_i32 s32, s32, 112
    s_lshl_b32 s33, s25, 3
    s_add_u32 s32, s32, s33
    s_lshl_b32 s33, s34, 1
    s_add_u32 s32, s32, s33
    s_lshl_b32 s36, s32, 10
    v_pk_mul_f32 v[92:93], v[36:37], v[114:115]
    v_pk_mul_f32 v[94:95], v[38:39], v[114:115]
    v_pk_mul_f32 v[96:97], v[40:41], v[114:115]
    v_pk_mul_f32 v[98:99], v[42:43], v[114:115]
    v_pk_mul_f32 v[84:85], v[92:93], v[92:93]
    v_pk_mul_f32 v[86:87], v[94:95], v[94:95]
    v_pk_mul_f32 v[88:89], v[96:97], v[96:97]
    v_pk_mul_f32 v[90:91], v[98:99], v[98:99]
    v_pk_fma_f32 v[84:85], v[84:85], v[110:111], v[108:109]
    v_pk_fma_f32 v[86:87], v[86:87], v[110:111], v[108:109]
    v_pk_fma_f32 v[88:89], v[88:89], v[110:111], v[108:109]
    v_pk_fma_f32 v[90:91], v[90:91], v[110:111], v[108:109]
    v_pk_mul_f32 v[84:85], v[92:93], v[84:85]
    v_pk_mul_f32 v[86:87], v[94:95], v[86:87]
    v_pk_mul_f32 v[88:89], v[96:97], v[88:89]
    v_pk_mul_f32 v[90:91], v[98:99], v[90:91]
    v_exp_f32 v84, v84
    v_exp_f32 v85, v85
    v_exp_f32 v86, v86
    v_exp_f32 v87, v87
    v_exp_f32 v88, v88
    v_exp_f32 v89, v89
    v_exp_f32 v90, v90
    v_exp_f32 v91, v91
    v_pk_add_f32 v[84:85], v[84:85], 1.0 op_sel_hi:[1,0]
    v_pk_add_f32 v[86:87], v[86:87], 1.0 op_sel_hi:[1,0]
    v_pk_add_f32 v[88:89], v[88:89], 1.0 op_sel_hi:[1,0]
    v_pk_add_f32 v[90:91], v[90:91], 1.0 op_sel_hi:[1,0]
    v_rcp_f32 v84, v84
    v_rcp_f32 v85, v85
    v_rcp_f32 v86, v86
    v_rcp_f32 v87, v87
    v_rcp_f32 v88, v88
    v_rcp_f32 v89, v89
    v_rcp_f32 v90, v90
    v_rcp_f32 v91, v91
    v_pk_mul_f32 v[84:85], v[92:93], v[84:85]
    v_pk_mul_f32 v[86:87], v[94:95], v[86:87]
    v_pk_mul_f32 v[88:89], v[96:97], v[88:89]
    v_pk_mul_f32 v[90:91], v[98:99], v[90:91]
    v_cvt_pk_bf16_f32 v100, v84, v85
    v_cvt_pk_bf16_f32 v101, v86, v87
    v_cvt_pk_bf16_f32 v102, v88, v89
    v_cvt_pk_bf16_f32 v103, v90, v91
    buffer_store_dwordx4 v[100:103], v10, s[16:19], s36 offen offset:0 sc1
    s_add_u32 m0, s22, 8192
    s_add_u32 s32, s21, 57344
    buffer_load_dwordx4 v11, s[40:43], s32 offen lds
    s_add_u32 m0, s22, 9216
    s_add_u32 s32, s21, 64512
    buffer_load_dwordx4 v11, s[40:43], s32 offen lds
    v_pk_mul_f32 v[92:93], v[44:45], v[114:115]
    v_pk_mul_f32 v[94:95], v[46:47], v[114:115]
    v_pk_mul_f32 v[96:97], v[48:49], v[114:115]
    v_pk_mul_f32 v[98:99], v[50:51], v[114:115]
    v_pk_mul_f32 v[84:85], v[92:93], v[92:93]
    v_pk_mul_f32 v[86:87], v[94:95], v[94:95]
    v_pk_mul_f32 v[88:89], v[96:97], v[96:97]
    v_pk_mul_f32 v[90:91], v[98:99], v[98:99]
    v_pk_fma_f32 v[84:85], v[84:85], v[110:111], v[108:109]
    v_pk_fma_f32 v[86:87], v[86:87], v[110:111], v[108:109]
    v_pk_fma_f32 v[88:89], v[88:89], v[110:111], v[108:109]
    v_pk_fma_f32 v[90:91], v[90:91], v[110:111], v[108:109]
    v_pk_mul_f32 v[84:85], v[92:93], v[84:85]
    v_pk_mul_f32 v[86:87], v[94:95], v[86:87]
    v_pk_mul_f32 v[88:89], v[96:97], v[88:89]
    v_pk_mul_f32 v[90:91], v[98:99], v[90:91]
    v_exp_f32 v84, v84
    v_exp_f32 v85, v85
    v_exp_f32 v86, v86
    v_exp_f32 v87, v87
    v_exp_f32 v88, v88
    v_exp_f32 v89, v89
    v_exp_f32 v90, v90
    v_exp_f32 v91, v91
    v_pk_add_f32 v[84:85], v[84:85], 1.0 op_sel_hi:[1,0]
    v_pk_add_f32 v[86:87], v[86:87], 1.0 op_sel_hi:[1,0]
    v_pk_add_f32 v[88:89], v[88:89], 1.0 op_sel_hi:[1,0]
    v_pk_add_f32 v[90:91], v[90:91], 1.0 op_sel_hi:[1,0]
    v_rcp_f32 v84, v84
    v_rcp_f32 v85, v85
    v_rcp_f32 v86, v86
    v_rcp_f32 v87, v87
    v_rcp_f32 v88, v88
    v_rcp_f32 v89, v89
    v_rcp_f32 v90, v90
    v_rcp_f32 v91, v91
    v_pk_mul_f32 v[84:85], v[92:93], v[84:85]
    v_pk_mul_f32 v[86:87], v[94:95], v[86:87]
    v_pk_mul_f32 v[88:89], v[96:97], v[88:89]
    v_pk_mul_f32 v[90:91], v[98:99], v[90:91]
    v_cvt_pk_bf16_f32 v104, v84, v85
    v_cvt_pk_bf16_f32 v105, v86, v87
    v_cvt_pk_bf16_f32 v106, v88, v89
    v_cvt_pk_bf16_f32 v107, v90, v91
    buffer_store_dwordx4 v[104:107], v10, s[16:19], s36 offen offset:1024 sc1
    s_add_u32 m0, s22, 10240
    s_add_u32 s32, s21, 71680
    buffer_load_dwordx4 v11, s[40:43], s32 offen lds
    s_add_u32 m0, s22, 11264
    s_add_u32 s32, s21, 78848
    buffer_load_dwordx4 v11, s[40:43], s32 offen lds
    s_xor_b32 s32, s28, 1
    s_lshl_b32 s33, s27, 1
    s_add_u32 s34, s32, s33
    s_xor_b32 s32, s27, 0
    s_lshl_b32 s33, s28, 1
    s_add_u32 s32, s32, s33
    s_lshl_b32 s33, s24, 2
    s_add_u32 s32, s32, s33
    s_mul_i32 s32, s32, 112
    s_lshl_b32 s33, s25, 3
    s_add_u32 s32, s32, s33
    s_lshl_b32 s33, s34, 1
    s_add_u32 s32, s32, s33
    s_lshl_b32 s36, s32, 10
    v_pk_mul_f32 v[92:93], v[52:53], v[112:113]
    v_pk_mul_f32 v[94:95], v[54:55], v[112:113]
    v_pk_mul_f32 v[96:97], v[56:57], v[112:113]
    v_pk_mul_f32 v[98:99], v[58:59], v[112:113]
    v_pk_mul_f32 v[84:85], v[92:93], v[92:93]
    v_pk_mul_f32 v[86:87], v[94:95], v[94:95]
    v_pk_mul_f32 v[88:89], v[96:97], v[96:97]
    v_pk_mul_f32 v[90:91], v[98:99], v[98:99]
    v_pk_fma_f32 v[84:85], v[84:85], v[110:111], v[108:109]
    v_pk_fma_f32 v[86:87], v[86:87], v[110:111], v[108:109]
    v_pk_fma_f32 v[88:89], v[88:89], v[110:111], v[108:109]
    v_pk_fma_f32 v[90:91], v[90:91], v[110:111], v[108:109]
    v_pk_mul_f32 v[84:85], v[92:93], v[84:85]
    v_pk_mul_f32 v[86:87], v[94:95], v[86:87]
    v_pk_mul_f32 v[88:89], v[96:97], v[88:89]
    v_pk_mul_f32 v[90:91], v[98:99], v[90:91]
    v_exp_f32 v84, v84
    v_exp_f32 v85, v85
    v_exp_f32 v86, v86
    v_exp_f32 v87, v87
    v_exp_f32 v88, v88
    v_exp_f32 v89, v89
    v_exp_f32 v90, v90
    v_exp_f32 v91, v91
    v_pk_add_f32 v[84:85], v[84:85], 1.0 op_sel_hi:[1,0]
    v_pk_add_f32 v[86:87], v[86:87], 1.0 op_sel_hi:[1,0]
    v_pk_add_f32 v[88:89], v[88:89], 1.0 op_sel_hi:[1,0]
    v_pk_add_f32 v[90:91], v[90:91], 1.0 op_sel_hi:[1,0]
    v_rcp_f32 v84, v84
    v_rcp_f32 v85, v85
    v_rcp_f32 v86, v86
    v_rcp_f32 v87, v87
    v_rcp_f32 v88, v88
    v_rcp_f32 v89, v89
    v_rcp_f32 v90, v90
    v_rcp_f32 v91, v91
    v_pk_mul_f32 v[84:85], v[92:93], v[84:85]
    v_pk_mul_f32 v[86:87], v[94:95], v[86:87]
    v_pk_mul_f32 v[88:89], v[96:97], v[88:89]
    v_pk_mul_f32 v[90:91], v[98:99], v[90:91]
    v_cvt_pk_bf16_f32 v100, v84, v85
    v_cvt_pk_bf16_f32 v101, v86, v87
    v_cvt_pk_bf16_f32 v102, v88, v89
    v_cvt_pk_bf16_f32 v103, v90, v91
    buffer_store_dwordx4 v[100:103], v10, s[16:19], s36 offen offset:0 sc1
    s_add_u32 m0, s22, 12288
    s_add_u32 s32, s21, 86016
    buffer_load_dwordx4 v11, s[40:43], s32 offen lds
    s_add_u32 m0, s22, 13312
    s_add_u32 s32, s21, 93184
    buffer_load_dwordx4 v11, s[40:43], s32 offen lds
    v_pk_mul_f32 v[92:93], v[60:61], v[112:113]
    v_pk_mul_f32 v[94:95], v[62:63], v[112:113]
    v_pk_mul_f32 v[96:97], v[64:65], v[112:113]
    v_pk_mul_f32 v[98:99], v[66:67], v[112:113]
    v_pk_mul_f32 v[84:85], v[92:93], v[92:93]
    v_pk_mul_f32 v[86:87], v[94:95], v[94:95]
    v_pk_mul_f32 v[88:89], v[96:97], v[96:97]
    v_pk_mul_f32 v[90:91], v[98:99], v[98:99]
    v_pk_fma_f32 v[84:85], v[84:85], v[110:111], v[108:109]
    v_pk_fma_f32 v[86:87], v[86:87], v[110:111], v[108:109]
    v_pk_fma_f32 v[88:89], v[88:89], v[110:111], v[108:109]
    v_pk_fma_f32 v[90:91], v[90:91], v[110:111], v[108:109]
    v_pk_mul_f32 v[84:85], v[92:93], v[84:85]
    v_pk_mul_f32 v[86:87], v[94:95], v[86:87]
    v_pk_mul_f32 v[88:89], v[96:97], v[88:89]
    v_pk_mul_f32 v[90:91], v[98:99], v[90:91]
    v_exp_f32 v84, v84
    v_exp_f32 v85, v85
    v_exp_f32 v86, v86
    v_exp_f32 v87, v87
    v_exp_f32 v88, v88
    v_exp_f32 v89, v89
    v_exp_f32 v90, v90
    v_exp_f32 v91, v91
    v_pk_add_f32 v[84:85], v[84:85], 1.0 op_sel_hi:[1,0]
    v_pk_add_f32 v[86:87], v[86:87], 1.0 op_sel_hi:[1,0]
    v_pk_add_f32 v[88:89], v[88:89], 1.0 op_sel_hi:[1,0]
    v_pk_add_f32 v[90:91], v[90:91], 1.0 op_sel_hi:[1,0]
    v_rcp_f32 v84, v84
    v_rcp_f32 v85, v85
    v_rcp_f32 v86, v86
    v_rcp_f32 v87, v87
    v_rcp_f32 v88, v88
    v_rcp_f32 v89, v89
    v_rcp_f32 v90, v90
    v_rcp_f32 v91, v91
    v_pk_mul_f32 v[84:85], v[92:93], v[84:85]
    v_pk_mul_f32 v[86:87], v[94:95], v[86:87]
    v_pk_mul_f32 v[88:89], v[96:97], v[88:89]
    v_pk_mul_f32 v[90:91], v[98:99], v[90:91]
    v_cvt_pk_bf16_f32 v104, v84, v85
    v_cvt_pk_bf16_f32 v105, v86, v87
    v_cvt_pk_bf16_f32 v106, v88, v89
    v_cvt_pk_bf16_f32 v107, v90, v91
    buffer_store_dwordx4 v[104:107], v10, s[16:19], s36 offen offset:1024 sc1
    s_add_u32 m0, s22, 14336
    s_add_u32 s32, s21, 100352
    buffer_load_dwordx4 v11, s[40:43], s32 offen lds
    s_add_u32 m0, s22, 15360
    s_add_u32 s32, s21, 107520
    buffer_load_dwordx4 v11, s[40:43], s32 offen lds
    s_xor_b32 s32, s27, 1
    s_lshl_b32 s33, s28, 1
    s_add_u32 s32, s32, s33
    s_lshl_b32 s33, s24, 2
    s_add_u32 s32, s32, s33
    s_mul_i32 s32, s32, 112
    s_lshl_b32 s33, s25, 3
    s_add_u32 s32, s32, s33
    s_lshl_b32 s33, s34, 1
    s_add_u32 s32, s32, s33
    s_lshl_b32 s36, s32, 10
    v_pk_mul_f32 v[92:93], v[68:69], v[114:115]
    v_pk_mul_f32 v[94:95], v[70:71], v[114:115]
    v_pk_mul_f32 v[96:97], v[72:73], v[114:115]
    v_pk_mul_f32 v[98:99], v[74:75], v[114:115]
    v_pk_mul_f32 v[84:85], v[92:93], v[92:93]
    v_pk_mul_f32 v[86:87], v[94:95], v[94:95]
    v_pk_mul_f32 v[88:89], v[96:97], v[96:97]
    v_pk_mul_f32 v[90:91], v[98:99], v[98:99]
    v_pk_fma_f32 v[84:85], v[84:85], v[110:111], v[108:109]
    v_pk_fma_f32 v[86:87], v[86:87], v[110:111], v[108:109]
    v_pk_fma_f32 v[88:89], v[88:89], v[110:111], v[108:109]
    v_pk_fma_f32 v[90:91], v[90:91], v[110:111], v[108:109]
    v_pk_mul_f32 v[84:85], v[92:93], v[84:85]
    v_pk_mul_f32 v[86:87], v[94:95], v[86:87]
    v_pk_mul_f32 v[88:89], v[96:97], v[88:89]
    v_pk_mul_f32 v[90:91], v[98:99], v[90:91]
    v_exp_f32 v84, v84
    v_exp_f32 v85, v85
    v_exp_f32 v86, v86
    v_exp_f32 v87, v87
    v_exp_f32 v88, v88
    v_exp_f32 v89, v89
    v_exp_f32 v90, v90
    v_exp_f32 v91, v91
    v_pk_add_f32 v[84:85], v[84:85], 1.0 op_sel_hi:[1,0]
    v_pk_add_f32 v[86:87], v[86:87], 1.0 op_sel_hi:[1,0]
    v_pk_add_f32 v[88:89], v[88:89], 1.0 op_sel_hi:[1,0]
    v_pk_add_f32 v[90:91], v[90:91], 1.0 op_sel_hi:[1,0]
    v_rcp_f32 v84, v84
    v_rcp_f32 v85, v85
    v_rcp_f32 v86, v86
    v_rcp_f32 v87, v87
    v_rcp_f32 v88, v88
    v_rcp_f32 v89, v89
    v_rcp_f32 v90, v90
    v_rcp_f32 v91, v91
    v_pk_mul_f32 v[84:85], v[92:93], v[84:85]
    v_pk_mul_f32 v[86:87], v[94:95], v[86:87]
    v_pk_mul_f32 v[88:89], v[96:97], v[88:89]
    v_pk_mul_f32 v[90:91], v[98:99], v[90:91]
    v_cvt_pk_bf16_f32 v100, v84, v85
    v_cvt_pk_bf16_f32 v101, v86, v87
    v_cvt_pk_bf16_f32 v102, v88, v89
    v_cvt_pk_bf16_f32 v103, v90, v91
    buffer_store_dwordx4 v[100:103], v10, s[16:19], s36 offen offset:0 sc1
    s_add_u32 m0, s22, 16384
    s_add_u32 s32, s21, 114688
    buffer_load_dwordx4 v11, s[40:43], s32 offen lds
    s_add_u32 m0, s22, 17408
    s_add_u32 s32, s21, 121856
    buffer_load_dwordx4 v11, s[40:43], s32 offen lds
    v_pk_mul_f32 v[92:93], v[76:77], v[114:115]
    v_pk_mul_f32 v[94:95], v[78:79], v[114:115]
    v_pk_mul_f32 v[96:97], v[80:81], v[114:115]
    v_pk_mul_f32 v[98:99], v[82:83], v[114:115]
    v_pk_mul_f32 v[84:85], v[92:93], v[92:93]
    v_pk_mul_f32 v[86:87], v[94:95], v[94:95]
    v_pk_mul_f32 v[88:89], v[96:97], v[96:97]
    v_pk_mul_f32 v[90:91], v[98:99], v[98:99]
    v_pk_fma_f32 v[84:85], v[84:85], v[110:111], v[108:109]
    v_pk_fma_f32 v[86:87], v[86:87], v[110:111], v[108:109]
    v_pk_fma_f32 v[88:89], v[88:89], v[110:111], v[108:109]
    v_pk_fma_f32 v[90:91], v[90:91], v[110:111], v[108:109]
    v_pk_mul_f32 v[84:85], v[92:93], v[84:85]
    v_pk_mul_f32 v[86:87], v[94:95], v[86:87]
    v_pk_mul_f32 v[88:89], v[96:97], v[88:89]
    v_pk_mul_f32 v[90:91], v[98:99], v[90:91]
    v_exp_f32 v84, v84
    v_exp_f32 v85, v85
    v_exp_f32 v86, v86
    v_exp_f32 v87, v87
    v_exp_f32 v88, v88
    v_exp_f32 v89, v89
    v_exp_f32 v90, v90
    v_exp_f32 v91, v91
    v_pk_add_f32 v[84:85], v[84:85], 1.0 op_sel_hi:[1,0]
    v_pk_add_f32 v[86:87], v[86:87], 1.0 op_sel_hi:[1,0]
    v_pk_add_f32 v[88:89], v[88:89], 1.0 op_sel_hi:[1,0]
    v_pk_add_f32 v[90:91], v[90:91], 1.0 op_sel_hi:[1,0]
    v_rcp_f32 v84, v84
    v_rcp_f32 v85, v85
    v_rcp_f32 v86, v86
    v_rcp_f32 v87, v87
    v_rcp_f32 v88, v88
    v_rcp_f32 v89, v89
    v_rcp_f32 v90, v90
    v_rcp_f32 v91, v91
    v_pk_mul_f32 v[84:85], v[92:93], v[84:85]
    v_pk_mul_f32 v[86:87], v[94:95], v[86:87]
    v_pk_mul_f32 v[88:89], v[96:97], v[88:89]
    v_pk_mul_f32 v[90:91], v[98:99], v[90:91]
    v_cvt_pk_bf16_f32 v104, v84, v85
    v_cvt_pk_bf16_f32 v105, v86, v87
    v_cvt_pk_bf16_f32 v106, v88, v89
    v_cvt_pk_bf16_f32 v107, v90, v91
    buffer_store_dwordx4 v[104:107], v10, s[16:19], s36 offen offset:1024 sc1
    s_add_u32 m0, s22, 18432
    s_add_u32 s32, s21, 129024
    buffer_load_dwordx4 v11, s[40:43], s32 offen lds
    s_add_u32 m0, s22, 19456
    s_add_u32 s32, s21, 136192
    buffer_load_dwordx4 v11, s[40:43], s32 offen lds
    s_setprio 0
    s_waitcnt vmcnt(2)
    s_barrier
    s_lshl_b32 s32, s24, 7
    s_add_u32 s32, s32, 12984320
    v_mov_b32 v12, s32
    s_cmp_lg_u32 s26, 0
    s_cbranch_scc1 L_h_pub_15
    s_mov_b64 exec, 1
    global_atomic_add v12, v14, s[16:17] sc1
    s_mov_b64 exec, -1
L_h_pub_15:
    ds_read_b64_tr_b16 v[116:117], v15 offset:0
    ds_read_b64_tr_b16 v[118:119], v15 offset:1024
    ds_read_b64_tr_b16 v[120:121], v16 offset:0
    ds_read_b64_tr_b16 v[122:123], v16 offset:1024
    ds_read_b64_tr_b16 v[124:125], v15 offset:2048
    ds_read_b64_tr_b16 v[126:127], v15 offset:3072
    ds_read_b64_tr_b16 v[128:129], v16 offset:2048
    ds_read_b64_tr_b16 v[130:131], v16 offset:3072
    ds_read_b64_tr_b16 v[132:133], v15 offset:4096
    ds_read_b64_tr_b16 v[134:135], v15 offset:5120
    ds_read_b64_tr_b16 v[136:137], v16 offset:4096
    ds_read_b64_tr_b16 v[138:139], v16 offset:5120
    s_waitcnt lgkmcnt(8)
    s_add_u32 m0, s22, 0
    s_add_u32 s32, s21, 143360
    buffer_load_dwordx4 v11, s[40:43], s32 offen lds
    s_add_u32 m0, s22, 1024
    s_add_u32 s32, s21, 150528
    buffer_load_dwordx4 v11, s[40:43], s32 offen lds
    ds_read_b64_tr_b16 v[140:141], v15 offset:6144
    ds_read_b64_tr_b16 v[142:143], v15 offset:7168
    ds_read_b64_tr_b16 v[144:145], v16 offset:6144
    ds_read_b64_tr_b16 v[146:147], v16 offset:7168
    s_waitcnt lgkmcnt(8)
    s_add_u32 m0, s22, 2048
    s_add_u32 s32, s21, 157696
    buffer_load_dwordx4 v11, s[40:43], s32 offen lds
    s_add_u32 m0, s22, 3072
    s_add_u32 s32, s21, 164864
    buffer_load_dwordx4 v11, s[40:43], s32 offen lds
    ds_read_b64_tr_b16 v[148:149], v15 offset:8192
    ds_read_b64_tr_b16 v[150:151], v15 offset:9216
    ds_read_b64_tr_b16 v[152:153], v16 offset:8192
    ds_read_b64_tr_b16 v[154:155], v16 offset:9216
    s_waitcnt lgkmcnt(8)
    s_add_u32 m0, s22, 4096
    s_add_u32 s32, s21, 172032
    buffer_load_dwordx4 v11, s[40:43], s32 offen lds
    s_add_u32 m0, s22, 5120
    s_add_u32 s32, s21, 179200
    buffer_load_dwordx4 v11, s[40:43], s32 offen lds
    ds_read_b64_tr_b16 v[156:157], v15 offset:10240
    ds_read_b64_tr_b16 v[158:159], v15 offset:11264
    ds_read_b64_tr_b16 v[160:161], v16 offset:10240
    ds_read_b64_tr_b16 v[162:163], v16 offset:11264
    s_waitcnt lgkmcnt(8)
    s_add_u32 m0, s22, 6144
    s_add_u32 s32, s21, 186368
    buffer_load_dwordx4 v11, s[40:43], s32 offen lds
    s_add_u32 m0, s22, 7168
    s_add_u32 s32, s21, 193536
    buffer_load_dwordx4 v11, s[40:43], s32 offen lds
    ds_read_b64_tr_b16 v[164:165], v15 offset:12288
    ds_read_b64_tr_b16 v[166:167], v15 offset:13312
    ds_read_b64_tr_b16 v[168:169], v16 offset:12288
    ds_read_b64_tr_b16 v[170:171], v16 offset:13312
    s_waitcnt lgkmcnt(8)
    s_add_u32 m0, s22, 8192
    s_add_u32 s32, s21, 200704
    buffer_load_dwordx4 v11, s[40:43], s32 offen lds
    s_add_u32 m0, s22, 9216
    s_add_u32 s32, s21, 207872
    buffer_load_dwordx4 v11, s[40:43], s32 offen lds
    ds_read_b64_tr_b16 v[172:173], v15 offset:14336
    ds_read_b64_tr_b16 v[174:175], v15 offset:15360
    ds_read_b64_tr_b16 v[176:177], v16 offset:14336
    ds_read_b64_tr_b16 v[178:179], v16 offset:15360
    s_waitcnt lgkmcnt(8)
    s_add_u32 m0, s22, 10240
    s_add_u32 s32, s21, 215040
    buffer_load_dwordx4 v11, s[40:43], s32 offen lds
    s_add_u32 m0, s22, 11264
    s_add_u32 s32, s21, 222208
    buffer_load_dwordx4 v11, s[40:43], s32 offen lds
    ds_read_b64_tr_b16 v[180:181], v15 offset:16384
    ds_read_b64_tr_b16 v[182:183], v15 offset:17408
    ds_read_b64_tr_b16 v[184:185], v16 offset:16384
    ds_read_b64_tr_b16 v[186:187], v16 offset:17408
    s_waitcnt lgkmcnt(8)
    s_add_u32 m0, s22, 12288
    s_add_u32 s32, s21, 229376
    buffer_load_dwordx4 v11, s[40:43], s32 offen lds
    s_add_u32 m0, s22, 13312
    s_add_u32 s32, s21, 236544
    buffer_load_dwordx4 v11, s[40:43], s32 offen lds
    s_waitcnt vmcnt(14)
    ds_read_b64_tr_b16 v[188:189], v15 offset:18432
    ds_read_b64_tr_b16 v[190:191], v15 offset:19456
    ds_read_b64_tr_b16 v[192:193], v16 offset:18432
    ds_read_b64_tr_b16 v[194:195], v16 offset:19456
    s_waitcnt lgkmcnt(8)
    s_add_u32 m0, s22, 14336
    s_add_u32 s32, s21, 243712
    buffer_load_dwordx4 v11, s[40:43], s32 offen lds
    s_add_u32 m0, s22, 15360
    s_add_u32 s32, s21, 250880
    buffer_load_dwordx4 v11, s[40:43], s32 offen lds
    s_waitcnt vmcnt(14)
    ds_read_b64_tr_b16 v[196:197], v15 offset:0
    ds_read_b64_tr_b16 v[198:199], v15 offset:1024
    ds_read_b64_tr_b16 v[200:201], v16 offset:0
    ds_read_b64_tr_b16 v[202:203], v16 offset:1024
    s_waitcnt lgkmcnt(8)
    s_add_u32 m0, s22, 16384
    s_add_u32 s32, s21, 258048
    buffer_load_dwordx4 v11, s[40:43], s32 offen lds
    s_add_u32 m0, s22, 17408
    s_add_u32 s32, s21, 265216
    buffer_load_dwordx4 v11, s[40:43], s32 offen lds
    s_waitcnt vmcnt(14)
    ds_read_b64_tr_b16 v[204:205], v15 offset:2048
    ds_read_b64_tr_b16 v[206:207], v15 offset:3072
    ds_read_b64_tr_b16 v[208:209], v16 offset:2048
    ds_read_b64_tr_b16 v[210:211], v16 offset:3072
    s_waitcnt lgkmcnt(8)
    s_add_u32 m0, s22, 18432
    s_add_u32 s32, s21, 272384
    buffer_load_dwordx4 v11, s[40:43], s32 offen lds
    s_add_u32 m0, s22, 19456
    s_add_u32 s32, s21, 279552
    buffer_load_dwordx4 v11, s[40:43], s32 offen lds
    s_waitcnt vmcnt(14)
    ds_read_b64_tr_b16 v[212:213], v15 offset:4096
    ds_read_b64_tr_b16 v[214:215], v15 offset:5120
    ds_read_b64_tr_b16 v[216:217], v16 offset:4096
    ds_read_b64_tr_b16 v[218:219], v16 offset:5120
    s_waitcnt lgkmcnt(8)
    s_add_u32 m0, s22, 0
    s_add_u32 s32, s21, 286720
    buffer_load_dwordx4 v11, s[40:43], s32 offen lds
    s_add_u32 m0, s22, 1024
    s_add_u32 s32, s21, 293888
    buffer_load_dwordx4 v11, s[40:43], s32 offen lds
    s_waitcnt lgkmcnt(4)
    s_add_u32 m0, s22, 2048
    s_add_u32 s32, s21, 301056
    buffer_load_dwordx4 v11, s[40:43], s32 offen lds
    s_add_u32 m0, s22, 3072
    s_add_u32 s32, s21, 308224
    buffer_load_dwordx4 v11, s[40:43], s32 offen lds
    s_waitcnt lgkmcnt(0)
    s_add_u32 m0, s22, 4096
    s_add_u32 s32, s21, 315392
    buffer_load_dwordx4 v11, s[40:43], s32 offen lds
    s_add_u32 m0, s22, 5120
    s_add_u32 s32, s21, 322560
    buffer_load_dwordx4 v11, s[40:43], s32 offen lds
    s_cmp_lg_u32 s26, 0
    s_cbranch_scc1 L_h_wait_16
    s_mov_b32 s88, 0x40000
L_spin_17:
    s_mov_b64 exec, 0x1
    global_load_dword v13, v12, s[16:17] sc1
    s_mov_b64 exec, -1
    s_waitcnt vmcnt(0)
    s_mov_b64 exec, 0x1
    v_cmp_le_u32 vcc, 14, v13
    s_nop 0
    s_cmp_eq_u64 vcc, exec
    s_mov_b64 exec, -1
    s_cbranch_scc1 L_spun_18
    s_sleep 2
    s_sub_u32 s88, s88, 1
    s_cmp_lg_u32 s88, 0
    s_cbranch_scc1 L_spin_17
L_spun_18:
L_h_wait_16:
    s_barrier
    s_add_u32 s32, s20, 0
    buffer_load_dwordx4 v[84:87], v10, s[16:19], s32 offen sc1
    s_add_u32 s32, s20, 114688
    buffer_load_dwordx4 v[88:91], v10, s[16:19], s32 offen sc1
    s_add_u32 s32, s20, 1024
    buffer_load_dwordx4 v[92:95], v10, s[16:19], s32 offen sc1
    s_add_u32 s32, s20, 115712
    buffer_load_dwordx4 v[96:99], v10, s[16:19], s32 offen sc1
    s_add_u32 s32, s20, 2048
    buffer_load_dwordx4 v[100:103], v10, s[16:19], s32 offen sc1
    s_add_u32 s32, s20, 116736
    buffer_load_dwordx4 v[104:107], v10, s[16:19], s32 offen sc1
    s_add_u32 s32, s20, 3072
    buffer_load_dwordx4 v[108:111], v10, s[16:19], s32 offen sc1
    s_add_u32 s32, s20, 117760
    buffer_load_dwordx4 v[112:115], v10, s[16:19], s32 offen sc1
    s_add_u32 s32, s20, 4096
    buffer_load_dwordx4 v[220:223], v10, s[16:19], s32 offen sc1
    s_add_u32 s32, s20, 118784
    buffer_load_dwordx4 v[224:227], v10, s[16:19], s32 offen sc1
    s_add_u32 s32, s20, 5120
    buffer_load_dwordx4 v[228:231], v10, s[16:19], s32 offen sc1
    s_add_u32 s32, s20, 119808
    buffer_load_dwordx4 v[232:235], v10, s[16:19], s32 offen sc1
    s_lshl_b32 s32, s39, 7
    s_add_u32 s32, s32, 12986368
    v_mov_b32 v12, s32
    s_waitcnt vmcnt(10)
    v_mfma_f32_32x32x16_bf16 v[20:35], v[116:119], v[84:87], 0
    v_mfma_f32_32x32x16_bf16 v[36:51], v[116:119], v[88:91], 0
    v_mfma_f32_32x32x16_bf16 v[52:67], v[120:123], v[84:87], 0
    v_mfma_f32_32x32x16_bf16 v[68:83], v[120:123], v[88:91], 0
    s_add_u32 s32, s20, 6144
    buffer_load_dwordx4 v[84:87], v10, s[16:19], s32 offen sc1
    s_add_u32 s32, s20, 120832
    buffer_load_dwordx4 v[88:91], v10, s[16:19], s32 offen sc1
    s_waitcnt vmcnt(10)
    v_mfma_f32_32x32x16_bf16 v[20:35], v[124:127], v[92:95], v[20:35]
    v_mfma_f32_32x32x16_bf16 v[36:51], v[124:127], v[96:99], v[36:51]
    v_mfma_f32_32x32x16_bf16 v[52:67], v[128:131], v[92:95], v[52:67]
    v_mfma_f32_32x32x16_bf16 v[68:83], v[128:131], v[96:99], v[68:83]
    s_add_u32 s32, s20, 7168
    buffer_load_dwordx4 v[92:95], v10, s[16:19], s32 offen sc1
    s_add_u32 s32, s20, 121856
    buffer_load_dwordx4 v[96:99], v10, s[16:19], s32 offen sc1
    s_waitcnt vmcnt(10)
    v_mfma_f32_32x32x16_bf16 v[20:35], v[132:135], v[100:103], v[20:35]
    v_mfma_f32_32x32x16_bf16 v[36:51], v[132:135], v[104:107], v[36:51]
    v_mfma_f32_32x32x16_bf16 v[52:67], v[136:139], v[100:103], v[52:67]
    v_mfma_f32_32x32x16_bf16 v[68:83], v[136:139], v[104:107], v[68:83]
    s_add_u32 s32, s20, 8192
    buffer_load_dwordx4 v[100:103], v10, s[16:19], s32 offen sc1
    s_add_u32 s32, s20, 122880
    buffer_load_dwordx4 v[104:107], v10, s[16:19], s32 offen sc1
    s_waitcnt vmcnt(10)
    v_mfma_f32_32x32x16_bf16 v[20:35], v[140:143], v[108:111], v[20:35]
    v_mfma_f32_32x32x16_bf16 v[36:51], v[140:143], v[112:115], v[36:51]
    v_mfma_f32_32x32x16_bf16 v[52:67], v[144:147], v[108:111], v[52:67]
    v_mfma_f32_32x32x16_bf16 v[68:83], v[144:147], v[112:115], v[68:83]
    s_add_u32 s32, s20, 9216
    buffer_load_dwordx4 v[108:111], v10, s[16:19], s32 offen sc1
    s_add_u32 s32, s20, 123904
    buffer_load_dwordx4 v[112:115], v10, s[16:19], s32 offen sc1
    s_waitcnt vmcnt(10)
    v_mfma_f32_32x32x16_bf16 v[20:35], v[148:151], v[220:223], v[20:35]
    v_mfma_f32_32x32x16_bf16 v[36:51], v[148:151], v[224:227], v[36:51]
    v_mfma_f32_32x32x16_bf16 v[52:67], v[152:155], v[220:223], v[52:67]
    v_mfma_f32_32x32x16_bf16 v[68:83], v[152:155], v[224:227], v[68:83]
    s_add_u32 s32, s20, 10240
    buffer_load_dwordx4 v[220:223], v10, s[16:19], s32 offen sc1
    s_add_u32 s32, s20, 124928
    buffer_load_dwordx4 v[224:227], v10, s[16:19], s32 offen sc1
    s_waitcnt vmcnt(10)
    v_mfma_f32_32x32x16_bf16 v[20:35], v[156:159], v[228:231], v[20:35]
    v_mfma_f32_32x32x16_bf16 v[36:51], v[156:159], v[232:235], v[36:51]
    v_mfma_f32_32x32x16_bf16 v[52:67], v[160:163], v[228:231], v[52:67]
    v_mfma_f32_32x32x16_bf16 v[68:83], v[160:163], v[232:235], v[68:83]
    s_add_u32 s32, s20, 11264
    buffer_load_dwordx4 v[228:231], v10, s[16:19], s32 offen sc1
    s_add_u32 s32, s20, 125952
    buffer_load_dwordx4 v[232:235], v10, s[16:19], s32 offen sc1
    v_lshrrev_b32 v4, 3, v0
    v_and_b32 v5, 7, v0
    v_mul_u32_u24 v136, 896, v4
    v_lshl_add_u32 v136, v5, 4, v136
    v_lshlrev_b32 v137, 15, v5
    v_bfe_u32 v6, v4, 2, 2
    v_lshl_add_u32 v137, v6, 8, v137
    v_lshrrev_b32 v6, 4, v4
    v_lshl_add_u32 v137, v6, 4, v137
    v_and_b32 v6, 3, v4
    v_lshl_add_u32 v137, v6, 2, v137
    buffer_load_dwordx4 v[116:119], v136, s[8:11], s23 offen
    buffer_load_dwordx4 v[120:123], v136, s[8:11], s59 offen
    v_lshlrev_b32 v6, 4, v5
    s_lshl_b32 s32, s39, 7
    buffer_load_dwordx4 v[128:131], v6, s[48:51], s32 offen
    buffer_load_dwordx4 v[132:135], v6, s[52:55], s32 offen
    v_lshlrev_b32 v4, 3, v4
    s_lshl_b32 s32, s38, 9
    s_add_u32 s32, s32, 12845056
    buffer_load_dwordx2 v[124:125], v4, s[16:19], s32 offen sc1
    buffer_load_dwordx2 v[126:127], v4, s[16:19], s32 offen offset:256 sc1
    s_waitcnt vmcnt(16)
    v_mfma_f32_32x32x16_bf16 v[20:35], v[164:167], v[84:87], v[20:35]
    v_mfma_f32_32x32x16_bf16 v[36:51], v[164:167], v[88:91], v[36:51]
    v_mfma_f32_32x32x16_bf16 v[52:67], v[168:171], v[84:87], v[52:67]
    v_mfma_f32_32x32x16_bf16 v[68:83], v[168:171], v[88:91], v[68:83]
    s_add_u32 s32, s20, 12288
    buffer_load_dwordx4 v[84:87], v10, s[16:19], s32 offen sc1
    s_add_u32 s32, s20, 126976
    buffer_load_dwordx4 v[88:91], v10, s[16:19], s32 offen sc1
    s_waitcnt vmcnt(16)
    v_mfma_f32_32x32x16_bf16 v[20:35], v[172:175], v[92:95], v[20:35]
    v_mfma_f32_32x32x16_bf16 v[36:51], v[172:175], v[96:99], v[36:51]
    v_mfma_f32_32x32x16_bf16 v[52:67], v[176:179], v[92:95], v[52:67]
    v_mfma_f32_32x32x16_bf16 v[68:83], v[176:179], v[96:99], v[68:83]
    s_add_u32 s32, s20, 13312
    buffer_load_dwordx4 v[92:95], v10, s[16:19], s32 offen sc1
    s_add_u32 s32, s20, 128000
    buffer_load_dwordx4 v[96:99], v10, s[16:19], s32 offen sc1
    s_waitcnt vmcnt(16)
    v_mfma_f32_32x32x16_bf16 v[20:35], v[180:183], v[100:103], v[20:35]
    v_mfma_f32_32x32x16_bf16 v[36:51], v[180:183], v[104:107], v[36:51]
    v_mfma_f32_32x32x16_bf16 v[52:67], v[184:187], v[100:103], v[52:67]
    v_mfma_f32_32x32x16_bf16 v[68:83], v[184:187], v[104:107], v[68:83]
    s_add_u32 s32, s20, 14336
    buffer_load_dwordx4 v[100:103], v10, s[16:19], s32 offen sc1
    s_add_u32 s32, s20, 129024
    buffer_load_dwordx4 v[104:107], v10, s[16:19], s32 offen sc1
    s_waitcnt vmcnt(16)
    v_mfma_f32_32x32x16_bf16 v[20:35], v[188:191], v[108:111], v[20:35]
    v_mfma_f32_32x32x16_bf16 v[36:51], v[188:191], v[112:115], v[36:51]
    v_mfma_f32_32x32x16_bf16 v[52:67], v[192:195], v[108:111], v[52:67]
    v_mfma_f32_32x32x16_bf16 v[68:83], v[192:195], v[112:115], v[68:83]
    s_add_u32 s32, s20, 15360
    buffer_load_dwordx4 v[108:111], v10, s[16:19], s32 offen sc1
    s_add_u32 s32, s20, 130048
    buffer_load_dwordx4 v[112:115], v10, s[16:19], s32 offen sc1
    s_waitcnt vmcnt(16)
    v_mfma_f32_32x32x16_bf16 v[20:35], v[196:199], v[220:223], v[20:35]
    v_mfma_f32_32x32x16_bf16 v[36:51], v[196:199], v[224:227], v[36:51]
    v_mfma_f32_32x32x16_bf16 v[52:67], v[200:203], v[220:223], v[52:67]
    v_mfma_f32_32x32x16_bf16 v[68:83], v[200:203], v[224:227], v[68:83]
    s_add_u32 s32, s20, 16384
    buffer_load_dwordx4 v[220:223], v10, s[16:19], s32 offen sc1
    s_add_u32 s32, s20, 131072
    buffer_load_dwordx4 v[224:227], v10, s[16:19], s32 offen sc1
    s_waitcnt vmcnt(16)
    v_mfma_f32_32x32x16_bf16 v[20:35], v[204:207], v[228:231], v[20:35]
    v_mfma_f32_32x32x16_bf16 v[36:51], v[204:207], v[232:235], v[36:51]
    v_mfma_f32_32x32x16_bf16 v[52:67], v[208:211], v[228:231], v[52:67]
    v_mfma_f32_32x32x16_bf16 v[68:83], v[208:211], v[232:235], v[68:83]
    s_add_u32 s32, s20, 17408
    buffer_load_dwordx4 v[228:231], v10, s[16:19], s32 offen sc1
    s_add_u32 s32, s20, 132096
    buffer_load_dwordx4 v[232:235], v10, s[16:19], s32 offen sc1
    s_waitcnt vmcnt(10)
    v_mfma_f32_32x32x16_bf16 v[20:35], v[212:215], v[84:87], v[20:35]
    ds_read_b64_tr_b16 v[244:245], v15 offset:6144
    ds_read_b64_tr_b16 v[246:247], v15 offset:7168
    v_mfma_f32_32x32x16_bf16 v[36:51], v[212:215], v[88:91], v[36:51]
    ds_read_b64_tr_b16 v[248:249], v16 offset:6144
    ds_read_b64_tr_b16 v[250:251], v16 offset:7168
    v_mfma_f32_32x32x16_bf16 v[52:67], v[216:219], v[84:87], v[52:67]
    v_mfma_f32_32x32x16_bf16 v[68:83], v[216:219], v[88:91], v[68:83]
    s_add_u32 s32, s20, 18432
    buffer_load_dwordx4 v[84:87], v10, s[16:19], s32 offen sc1
    s_add_u32 s32, s20, 133120
    buffer_load_dwordx4 v[88:91], v10, s[16:19], s32 offen sc1
    s_waitcnt vmcnt(10)
    s_waitcnt lgkmcnt(0)
    v_mfma_f32_32x32x16_bf16 v[20:35], v[244:247], v[92:95], v[20:35]
    ds_read_b64_tr_b16 v[236:237], v15 offset:8192
    ds_read_b64_tr_b16 v[238:239], v15 offset:9216
    v_mfma_f32_32x32x16_bf16 v[36:51], v[244:247], v[96:99], v[36:51]
    ds_read_b64_tr_b16 v[240:241], v16 offset:8192
    ds_read_b64_tr_b16 v[242:243], v16 offset:9216
    s_add_u32 m0, s22, 6144
    s_add_u32 s32, s21, 329728
    buffer_load_dwordx4 v11, s[40:43], s32 offen lds
    s_add_u32 m0, s22, 7168
    s_add_u32 s32, s21, 336896
    buffer_load_dwordx4 v11, s[40:43], s32 offen lds
    v_mfma_f32_32x32x16_bf16 v[52:67], v[248:251], v[92:95], v[52:67]
    v_mfma_f32_32x32x16_bf16 v[68:83], v[248:251], v[96:99], v[68:83]
    s_add_u32 s32, s20, 19456
    buffer_load_dwordx4 v[92:95], v10, s[16:19], s32 offen sc1
    s_add_u32 s32, s20, 134144
    buffer_load_dwordx4 v[96:99], v10, s[16:19], s32 offen sc1
    s_waitcnt vmcnt(12)
    s_waitcnt lgkmcnt(0)
    v_mfma_f32_32x32x16_bf16 v[20:35], v[236:239], v[100:103], v[20:35]
    ds_read_b64_tr_b16 v[244:245], v15 offset:10240
    ds_read_b64_tr_b16 v[246:247], v15 offset:11264
    v_mfma_f32_32x32x16_bf16 v[36:51], v[236:239], v[104:107], v[36:51]
    ds_read_b64_tr_b16 v[248:249], v16 offset:10240
    ds_read_b64_tr_b16 v[250:251], v16 offset:11264
    s_add_u32 m0, s22, 8192
    s_add_u32 s32, s21, 344064
    buffer_load_dwordx4 v11, s[40:43], s32 offen lds
    s_add_u32 m0, s22, 9216
    s_add_u32 s32, s21, 351232
    buffer_load_dwordx4 v11, s[40:43], s32 offen lds
    v_mfma_f32_32x32x16_bf16 v[52:67], v[240:243], v[100:103], v[52:67]
    v_mfma_f32_32x32x16_bf16 v[68:83], v[240:243], v[104:107], v[68:83]
    s_add_u32 s32, s20, 20480
    buffer_load_dwordx4 v[100:103], v10, s[16:19], s32 offen sc1
    s_add_u32 s32, s20, 135168
    buffer_load_dwordx4 v[104:107], v10, s[16:19], s32 offen sc1
    s_waitcnt vmcnt(14)
    s_waitcnt lgkmcnt(0)
    v_mfma_f32_32x32x16_bf16 v[20:35], v[244:247], v[108:111], v[20:35]
    ds_read_b64_tr_b16 v[236:237], v15 offset:12288
    ds_read_b64_tr_b16 v[238:239], v15 offset:13312
    v_mfma_f32_32x32x16_bf16 v[36:51], v[244:247], v[112:115], v[36:51]
    ds_read_b64_tr_b16 v[240:241], v16 offset:12288
    ds_read_b64_tr_b16 v[242:243], v16 offset:13312
    s_add_u32 m0, s22, 10240
    s_add_u32 s32, s21, 358400
    buffer_load_dwordx4 v11, s[40:43], s32 offen lds
    s_add_u32 m0, s22, 11264
    s_add_u32 s32, s21, 365568
    buffer_load_dwordx4 v11, s[40:43], s32 offen lds
    v_mfma_f32_32x32x16_bf16 v[52:67], v[248:251], v[108:111], v[52:67]
    v_mfma_f32_32x32x16_bf16 v[68:83], v[248:251], v[112:115], v[68:83]
    s_add_u32 s32, s20, 21504
    buffer_load_dwordx4 v[108:111], v10, s[16:19], s32 offen sc1
    s_add_u32 s32, s20, 136192
    buffer_load_dwordx4 v[112:115], v10, s[16:19], s32 offen sc1
    s_waitcnt vmcnt(16)
    s_waitcnt lgkmcnt(0)
    v_mfma_f32_32x32x16_bf16 v[20:35], v[236:239], v[220:223], v[20:35]
    ds_read_b64_tr_b16 v[244:245], v15 offset:14336
    ds_read_b64_tr_b16 v[246:247], v15 offset:15360
    v_mfma_f32_32x32x16_bf16 v[36:51], v[236:239], v[224:227], v[36:51]
    ds_read_b64_tr_b16 v[248:249], v16 offset:14336
    ds_read_b64_tr_b16 v[250:251], v16 offset:15360
    s_add_u32 m0, s22, 12288
    s_add_u32 s32, s21, 372736
    buffer_load_dwordx4 v11, s[40:43], s32 offen lds
    s_add_u32 m0, s22, 13312
    s_add_u32 s32, s21, 379904
    buffer_load_dwordx4 v11, s[40:43], s32 offen lds
    v_mfma_f32_32x32x16_bf16 v[52:67], v[240:243], v[220:223], v[52:67]
    v_mfma_f32_32x32x16_bf16 v[68:83], v[240:243], v[224:227], v[68:83]
    s_add_u32 s32, s20, 22528
    buffer_load_dwordx4 v[220:223], v10, s[16:19], s32 offen sc1
    s_add_u32 s32, s20, 137216
    buffer_load_dwordx4 v[224:227], v10, s[16:19], s32 offen sc1
    s_waitcnt vmcnt(18)
    s_waitcnt lgkmcnt(0)
    v_mfma_f32_32x32x16_bf16 v[20:35], v[244:247], v[228:231], v[20:35]
    ds_read_b64_tr_b16 v[236:237], v15 offset:16384
    ds_read_b64_tr_b16 v[238:239], v15 offset:17408
    v_mfma_f32_32x32x16_bf16 v[36:51], v[244:247], v[232:235], v[36:51]
    ds_read_b64_tr_b16 v[240:241], v16 offset:16384
    ds_read_b64_tr_b16 v[242:243], v16 offset:17408
    s_add_u32 m0, s22, 14336
    s_add_u32 s32, s21, 387072
    buffer_load_dwordx4 v11, s[40:43], s32 offen lds
    s_add_u32 m0, s22, 15360
    s_add_u32 s32, s21, 394240
    buffer_load_dwordx4 v11, s[40:43], s32 offen lds
    v_mfma_f32_32x32x16_bf16 v[52:67], v[248:251], v[228:231], v[52:67]
    v_mfma_f32_32x32x16_bf16 v[68:83], v[248:251], v[232:235], v[68:83]
    s_add_u32 s32, s20, 23552
    buffer_load_dwordx4 v[228:231], v10, s[16:19], s32 offen sc1
    s_add_u32 s32, s20, 138240
    buffer_load_dwordx4 v[232:235], v10, s[16:19], s32 offen sc1
    s_waitcnt vmcnt(20)
    s_waitcnt lgkmcnt(0)
    v_mfma_f32_32x32x16_bf16 v[20:35], v[236:239], v[84:87], v[20:35]
    ds_read_b64_tr_b16 v[244:245], v15 offset:18432
    ds_read_b64_tr_b16 v[246:247], v15 offset:19456
    v_mfma_f32_32x32x16_bf16 v[36:51], v[236:239], v[88:91], v[36:51]
    ds_read_b64_tr_b16 v[248:249], v16 offset:18432
    ds_read_b64_tr_b16 v[250:251], v16 offset:19456
    v_mfma_f32_32x32x16_bf16 v[52:67], v[240:243], v[84:87], v[52:67]
    v_mfma_f32_32x32x16_bf16 v[68:83], v[240:243], v[88:91], v[68:83]
    s_add_u32 s32, s20, 24576
    buffer_load_dwordx4 v[84:87], v10, s[16:19], s32 offen sc1
    s_add_u32 s32, s20, 139264
    buffer_load_dwordx4 v[88:91], v10, s[16:19], s32 offen sc1
    s_waitcnt vmcnt(18)
    s_waitcnt lgkmcnt(0)
    v_mfma_f32_32x32x16_bf16 v[20:35], v[244:247], v[92:95], v[20:35]
    ds_read_b64_tr_b16 v[236:237], v15 offset:0
    ds_read_b64_tr_b16 v[238:239], v15 offset:1024
    v_mfma_f32_32x32x16_bf16 v[36:51], v[244:247], v[96:99], v[36:51]
    ds_read_b64_tr_b16 v[240:241], v16 offset:0
    ds_read_b64_tr_b16 v[242:243], v16 offset:1024
    v_mfma_f32_32x32x16_bf16 v[52:67], v[248:251], v[92:95], v[52:67]
    v_mfma_f32_32x32x16_bf16 v[68:83], v[248:251], v[96:99], v[68:83]
    s_add_u32 s32, s20, 25600
    buffer_load_dwordx4 v[92:95], v10, s[16:19], s32 offen sc1
    s_add_u32 s32, s20, 140288
    buffer_load_dwordx4 v[96:99], v10, s[16:19], s32 offen sc1
    s_waitcnt vmcnt(16)
    s_waitcnt lgkmcnt(0)
    v_mfma_f32_32x32x16_bf16 v[20:35], v[236:239], v[100:103], v[20:35]
    ds_read_b64_tr_b16 v[244:245], v15 offset:2048
    ds_read_b64_tr_b16 v[246:247], v15 offset:3072
    v_mfma_f32_32x32x16_bf16 v[36:51], v[236:239], v[104:107], v[36:51]
    ds_read_b64_tr_b16 v[248:249], v16 offset:2048
    ds_read_b64_tr_b16 v[250:251], v16 offset:3072
    v_mfma_f32_32x32x16_bf16 v[52:67], v[240:243], v[100:103], v[52:67]
    v_mfma_f32_32x32x16_bf16 v[68:83], v[240:243], v[104:107], v[68:83]
    s_add_u32 s32, s20, 26624
    buffer_load_dwordx4 v[100:103], v10, s[16:19], s32 offen sc1
    s_add_u32 s32, s20, 141312
    buffer_load_dwordx4 v[104:107], v10, s[16:19], s32 offen sc1
    s_waitcnt vmcnt(14)
    s_waitcnt lgkmcnt(0)
    v_mfma_f32_32x32x16_bf16 v[20:35], v[244:247], v[108:111], v[20:35]
    ds_read_b64_tr_b16 v[236:237], v15 offset:4096
    ds_read_b64_tr_b16 v[238:239], v15 offset:5120
    v_mfma_f32_32x32x16_bf16 v[36:51], v[244:247], v[112:115], v[36:51]
    ds_read_b64_tr_b16 v[240:241], v16 offset:4096
    ds_read_b64_tr_b16 v[242:243], v16 offset:5120
    v_mfma_f32_32x32x16_bf16 v[52:67], v[248:251], v[108:111], v[52:67]
    v_mfma_f32_32x32x16_bf16 v[68:83], v[248:251], v[112:115], v[68:83]
    s_add_u32 s32, s20, 27648
    buffer_load_dwordx4 v[108:111], v10, s[16:19], s32 offen sc1
    s_add_u32 s32, s20, 142336
    buffer_load_dwordx4 v[112:115], v10, s[16:19], s32 offen sc1
    s_waitcnt vmcnt(12)
    s_waitcnt lgkmcnt(0)
    v_mfma_f32_32x32x16_bf16 v[20:35], v[236:239], v[220:223], v[20:35]
    ds_read_b64_tr_b16 v[244:245], v15 offset:6144
    ds_read_b64_tr_b16 v[246:247], v15 offset:7168
    v_mfma_f32_32x32x16_bf16 v[36:51], v[236:239], v[224:227], v[36:51]
    ds_read_b64_tr_b16 v[248:249], v16 offset:6144
    ds_read_b64_tr_b16 v[250:251], v16 offset:7168
    v_mfma_f32_32x32x16_bf16 v[52:67], v[240:243], v[220:223], v[52:67]
    v_mfma_f32_32x32x16_bf16 v[68:83], v[240:243], v[224:227], v[68:83]
    s_mov_b64 exec, 0x1
    global_load_dword v13, v12, s[16:17] sc1
    s_mov_b64 exec, -1
    s_waitcnt vmcnt(9)
    s_waitcnt lgkmcnt(0)
    v_mfma_f32_32x32x16_bf16 v[20:35], v[244:247], v[228:231], v[20:35]
    ds_read_b64_tr_b16 v[236:237], v15 offset:8192
    ds_read_b64_tr_b16 v[238:239], v15 offset:9216
    v_mfma_f32_32x32x16_bf16 v[36:51], v[244:247], v[232:235], v[36:51]
    ds_read_b64_tr_b16 v[240:241], v16 offset:8192
    ds_read_b64_tr_b16 v[242:243], v16 offset:9216
    v_mfma_f32_32x32x16_bf16 v[52:67], v[248:251], v[228:231], v[52:67]
    v_mfma_f32_32x32x16_bf16 v[68:83], v[248:251], v[232:235], v[68:83]
    s_waitcnt vmcnt(7)
    s_waitcnt lgkmcnt(0)
    v_mfma_f32_32x32x16_bf16 v[20:35], v[236:239], v[84:87], v[20:35]
    ds_read_b64_tr_b16 v[244:245], v15 offset:10240
    ds_read_b64_tr_b16 v[246:247], v15 offset:11264
    v_mfma_f32_32x32x16_bf16 v[36:51], v[236:239], v[88:91], v[36:51]
    ds_read_b64_tr_b16 v[248:249], v16 offset:10240
    ds_read_b64_tr_b16 v[250:251], v16 offset:11264
    v_mfma_f32_32x32x16_bf16 v[52:67], v[240:243], v[84:87], v[52:67]
    v_mfma_f32_32x32x16_bf16 v[68:83], v[240:243], v[88:91], v[68:83]
    s_waitcnt vmcnt(5)
    s_waitcnt lgkmcnt(0)
    v_mfma_f32_32x32x16_bf16 v[20:35], v[244:247], v[92:95], v[20:35]
    ds_read_b64_tr_b16 v[236:237], v15 offset:12288
    ds_read_b64_tr_b16 v[238:239], v15 offset:13312
    v_mfma_f32_32x32x16_bf16 v[36:51], v[244:247], v[96:99], v[36:51]
    ds_read_b64_tr_b16 v[240:241], v16 offset:12288
    ds_read_b64_tr_b16 v[242:243], v16 offset:13312
    v_mfma_f32_32x32x16_bf16 v[52:67], v[248:251], v[92:95], v[52:67]
    v_mfma_f32_32x32x16_bf16 v[68:83], v[248:251], v[96:99], v[68:83]
    s_waitcnt vmcnt(0)
    s_mov_b64 exec, 0x1
    v_cmp_le_u32 vcc, 32, v13
    s_nop 0
    s_cmp_eq_u64 vcc, exec
    s_mov_b64 exec, -1
    s_cselect_b32 s37, 1, 0
    s_lshl_b32 s32, s39, 18
    s_lshr_b32 s33, s38, 2
    s_lshl_b32 s33, s33, 10
    s_add_u32 s32, s32, s33
    s_and_b32 s33, s38, 3
    s_lshl_b32 s33, s33, 6
    s_add_u32 s32, s32, s33
    s_add_u32 s32, s32, 11010048
    s_add_u32 s33, s32, 0
    buffer_load_dword v140, v137, s[16:19], s33 offen sc1
    s_add_u32 s33, s32, 8192
    buffer_load_dword v141, v137, s[16:19], s33 offen sc1
    s_add_u32 s33, s32, 16384
    buffer_load_dword v142, v137, s[16:19], s33 offen sc1
    s_add_u32 s33, s32, 24576
    buffer_load_dword v143, v137, s[16:19], s33 offen sc1
    s_add_u32 s33, s32, 32
    buffer_load_dword v144, v137, s[16:19], s33 offen sc1
    s_add_u32 s33, s32, 8224
    buffer_load_dword v145, v137, s[16:19], s33 offen sc1
    s_add_u32 s33, s32, 16416
    buffer_load_dword v146, v137, s[16:19], s33 offen sc1
    s_add_u32 s33, s32, 24608
    buffer_load_dword v147, v137, s[16:19], s33 offen sc1
    s_waitcnt lgkmcnt(0)
    v_mfma_f32_32x32x16_bf16 v[20:35], v[236:239], v[100:103], v[20:35]
    ds_read_b64_tr_b16 v[244:245], v15 offset:14336
    ds_read_b64_tr_b16 v[246:247], v15 offset:15360
    v_mfma_f32_32x32x16_bf16 v[36:51], v[236:239], v[104:107], v[36:51]
    ds_read_b64_tr_b16 v[248:249], v16 offset:14336
    ds_read_b64_tr_b16 v[250:251], v16 offset:15360
    v_mfma_f32_32x32x16_bf16 v[52:67], v[240:243], v[100:103], v[52:67]
    v_mfma_f32_32x32x16_bf16 v[68:83], v[240:243], v[104:107], v[68:83]
    s_waitcnt lgkmcnt(0)
    v_mfma_f32_32x32x16_bf16 v[20:35], v[244:247], v[108:111], v[20:35]
    v_mfma_f32_32x32x16_bf16 v[36:51], v[244:247], v[112:115], v[36:51]
    v_mfma_f32_32x32x16_bf16 v[52:67], v[248:251], v[108:111], v[52:67]
    v_mfma_f32_32x32x16_bf16 v[68:83], v[248:251], v[112:115], v[68:83]
    v_and_b32 v4, 31, v3
    v_mul_u32_u24 v4, 272, v4
    v_lshrrev_b32 v5, 5, v3
    v_lshl_add_u32 v4, v5, 4, v4
    v_add_u32 v4, s22, v4
    s_nop 3
    ds_write_b128 v4, v[20:23] offset:0
    ds_write_b128 v4, v[24:27] offset:32
    ds_write_b128 v4, v[28:31] offset:64
    ds_write_b128 v4, v[32:35] offset:96
    ds_write_b128 v4, v[36:39] offset:8704
    ds_write_b128 v4, v[40:43] offset:8736
    ds_write_b128 v4, v[44:47] offset:8768
    ds_write_b128 v4, v[48:51] offset:8800
    ds_write_b128 v4, v[52:55] offset:128
    ds_write_b128 v4, v[56:59] offset:160
    ds_write_b128 v4, v[60:63] offset:192
    ds_write_b128 v4, v[64:67] offset:224
    ds_write_b128 v4, v[68:71] offset:8832
    ds_write_b128 v4, v[72:75] offset:8864
    ds_write_b128 v4, v[76:79] offset:8896
    ds_write_b128 v4, v[80:83] offset:8928
    s_cmp_eq_u32 s37, 1
    s_cbranch_scc1 L_y_ok_19
    s_mov_b32 s88, 0x40000
L_spin_20:
    s_mov_b64 exec, 0x1
    global_load_dword v13, v12, s[16:17] sc1
    s_mov_b64 exec, -1
    s_waitcnt vmcnt(0)
    s_mov_b64 exec, 0x1
    v_cmp_le_u32 vcc, 32, v13
    s_nop 0
    s_cmp_eq_u64 vcc, exec
    s_mov_b64 exec, -1
    s_cbranch_scc1 L_spun_21
    s_sleep 8
    s_sub_u32 s88, s88, 1
    s_cmp_lg_u32 s88, 0
    s_cbranch_scc1 L_spin_20
L_spun_21:
    s_lshl_b32 s32, s39, 18
    s_lshr_b32 s33, s38, 2
    s_lshl_b32 s33, s33, 10
    s_add_u32 s32, s32, s33
    s_and_b32 s33, s38, 3
    s_lshl_b32 s33, s33, 6
    s_add_u32 s32, s32, s33
    s_add_u32 s32, s32, 11010048
    s_add_u32 s33, s32, 0
    buffer_load_dword v140, v137, s[16:19], s33 offen sc1
    s_add_u32 s33, s32, 8192
    buffer_load_dword v141, v137, s[16:19], s33 offen sc1
    s_add_u32 s33, s32, 16384
    buffer_load_dword v142, v137, s[16:19], s33 offen sc1
    s_add_u32 s33, s32, 24576
    buffer_load_dword v143, v137, s[16:19], s33 offen sc1
    s_add_u32 s33, s32, 32
    buffer_load_dword v144, v137, s[16:19], s33 offen sc1
    s_add_u32 s33, s32, 8224
    buffer_load_dword v145, v137, s[16:19], s33 offen sc1
    s_add_u32 s33, s32, 16416
    buffer_load_dword v146, v137, s[16:19], s33 offen sc1
    s_add_u32 s33, s32, 24608
    buffer_load_dword v147, v137, s[16:19], s33 offen sc1
L_y_ok_19:
    s_waitcnt vmcnt(0)
    s_waitcnt lgkmcnt(0)
    v_lshlrev_b32 v20, 16, v128
    v_and_b32 v21, 0xffff0000, v128
    v_lshlrev_b32 v28, 16, v132
    v_and_b32 v29, 0xffff0000, v132
    v_lshlrev_b32 v22, 16, v129
    v_and_b32 v23, 0xffff0000, v129
    v_lshlrev_b32 v30, 16, v133
    v_and_b32 v31, 0xffff0000, v133
    v_lshlrev_b32 v24, 16, v130
    v_and_b32 v25, 0xffff0000, v130
    v_lshlrev_b32 v32, 16, v134
    v_and_b32 v33, 0xffff0000, v134
    v_lshlrev_b32 v26, 16, v131
    v_and_b32 v27, 0xffff0000, v131
    v_lshlrev_b32 v34, 16, v135
    v_and_b32 v35, 0xffff0000, v135
    s_barrier
    v_lshrrev_b32 v4, 3, v0
    v_mul_u32_u24 v4, 272, v4
    v_and_b32 v5, 7, v0
    v_lshl_add_u32 v4, v5, 5, v4
    v_add_u32 v7, 61440, v4
    ds_read_b128 v[36:39], v4 offset:0
    ds_read_b128 v[40:43], v4 offset:16
    ds_read_b128 v[44:47], v4 offset:20480
    ds_read_b128 v[48:51], v4 offset:20496
    ds_read_b128 v[52:55], v4 offset:40960
    ds_read_b128 v[56:59], v4 offset:40976
    ds_read_b128 v[60:63], v7 offset:0
    ds_read_b128 v[64:67], v7 offset:16
    v_lshlrev_b32 v68, 16, v116
    v_and_b32 v69, 0xffff0000, v116
    v_lshlrev_b32 v76, 16, v140
    v_and_b32 v77, 0xffff0000, v140
    v_lshlrev_b32 v70, 16, v117
    v_and_b32 v71, 0xffff0000, v117
    v_lshlrev_b32 v78, 16, v141
    v_and_b32 v79, 0xffff0000, v141
    v_lshlrev_b32 v72, 16, v118
    v_and_b32 v73, 0xffff0000, v118
    v_lshlrev_b32 v80, 16, v142
    v_and_b32 v81, 0xffff0000, v142
    v_lshlrev_b32 v74, 16, v119
    v_and_b32 v75, 0xffff0000, v119
    v_lshlrev_b32 v82, 16, v143
    v_and_b32 v83, 0xffff0000, v143
    v_pk_add_f32 v[76:77], v[76:77], v[68:69]
    v_pk_add_f32 v[78:79], v[78:79], v[70:71]
    v_pk_add_f32 v[80:81], v[80:81], v[72:73]
    v_pk_add_f32 v[82:83], v[82:83], v[74:75]
    v_pk_add_f32 v[68:69], v[68:69], v[124:125] op_sel_hi:[1,0] neg_lo:[0,1] neg_hi:[0,1]
    v_pk_add_f32 v[70:71], v[70:71], v[124:125] op_sel_hi:[1,0] neg_lo:[0,1] neg_hi:[0,1]
    v_pk_add_f32 v[72:73], v[72:73], v[124:125] op_sel_hi:[1,0] neg_lo:[0,1] neg_hi:[0,1]
    v_pk_add_f32 v[74:75], v[74:75], v[124:125] op_sel_hi:[1,0] neg_lo:[0,1] neg_hi:[0,1]
    v_mov_b32 v124, v125
    v_pk_mul_f32 v[68:69], v[68:69], v[124:125]
    v_pk_mul_f32 v[70:71], v[70:71], v[124:125]
    v_pk_mul_f32 v[72:73], v[72:73], v[124:125]
    v_pk_mul_f32 v[74:75], v[74:75], v[124:125]
    v_pk_fma_f32 v[76:77], v[68:69], v[20:21], v[76:77]
    v_pk_fma_f32 v[78:79], v[70:71], v[22:23], v[78:79]
    v_pk_fma_f32 v[80:81], v[72:73], v[24:25], v[80:81]
    v_pk_fma_f32 v[82:83], v[74:75], v[26:27], v[82:83]
    v_pk_add_f32 v[76:77], v[76:77], v[28:29]
    v_pk_add_f32 v[78:79], v[78:79], v[30:31]
    v_pk_add_f32 v[80:81], v[80:81], v[32:33]
    v_pk_add_f32 v[82:83], v[82:83], v[34:35]
    s_waitcnt lgkmcnt(0)
    v_pk_add_f32 v[36:37], v[36:37], v[44:45]
    v_pk_add_f32 v[38:39], v[38:39], v[46:47]
    v_pk_add_f32 v[40:41], v[40:41], v[48:49]
    v_pk_add_f32 v[42:43], v[42:43], v[50:51]
    v_pk_add_f32 v[52:53], v[52:53], v[60:61]
    v_pk_add_f32 v[54:55], v[54:55], v[62:63]
    v_pk_add_f32 v[56:57], v[56:57], v[64:65]
    v_pk_add_f32 v[58:59], v[58:59], v[66:67]
    v_pk_add_f32 v[36:37], v[36:37], v[52:53]
    v_pk_add_f32 v[38:39], v[38:39], v[54:55]
    v_pk_add_f32 v[40:41], v[40:41], v[56:57]
    v_pk_add_f32 v[42:43], v[42:43], v[58:59]
    v_pk_add_f32 v[76:77], v[76:77], v[36:37]
    v_pk_add_f32 v[78:79], v[78:79], v[38:39]
    v_pk_add_f32 v[80:81], v[80:81], v[40:41]
    v_pk_add_f32 v[82:83], v[82:83], v[42:43]
    v_cvt_pk_bf16_f32 v84, v76, v77
    v_cvt_pk_bf16_f32 v85, v78, v79
    v_cvt_pk_bf16_f32 v86, v80, v81
    v_cvt_pk_bf16_f32 v87, v82, v83
    buffer_store_dwordx4 v[84:87], v136, s[44:47], s23 offen
    ds_read_b128 v[36:39], v4 offset:8704
    ds_read_b128 v[40:43], v4 offset:8720
    ds_read_b128 v[44:47], v4 offset:29184
    ds_read_b128 v[48:51], v4 offset:29200
    ds_read_b128 v[52:55], v4 offset:49664
    ds_read_b128 v[56:59], v4 offset:49680
    ds_read_b128 v[60:63], v7 offset:8704
    ds_read_b128 v[64:67], v7 offset:8720
    v_lshlrev_b32 v68, 16, v120
    v_and_b32 v69, 0xffff0000, v120
    v_lshlrev_b32 v76, 16, v144
    v_and_b32 v77, 0xffff0000, v144
    v_lshlrev_b32 v70, 16, v121
    v_and_b32 v71, 0xffff0000, v121
    v_lshlrev_b32 v78, 16, v145
    v_and_b32 v79, 0xffff0000, v145
    v_lshlrev_b32 v72, 16, v122
    v_and_b32 v73, 0xffff0000, v122
    v_lshlrev_b32 v80, 16, v146
    v_and_b32 v81, 0xffff0000, v146
    v_lshlrev_b32 v74, 16, v123
    v_and_b32 v75, 0xffff0000, v123
    v_lshlrev_b32 v82, 16, v147
    v_and_b32 v83, 0xffff0000, v147
    v_pk_add_f32 v[76:77], v[76:77], v[68:69]
    v_pk_add_f32 v[78:79], v[78:79], v[70:71]
    v_pk_add_f32 v[80:81], v[80:81], v[72:73]
    v_pk_add_f32 v[82:83], v[82:83], v[74:75]
    v_pk_add_f32 v[68:69], v[68:69], v[126:127] op_sel_hi:[1,0] neg_lo:[0,1] neg_hi:[0,1]
    v_pk_add_f32 v[70:71], v[70:71], v[126:127] op_sel_hi:[1,0] neg_lo:[0,1] neg_hi:[0,1]
    v_pk_add_f32 v[72:73], v[72:73], v[126:127] op_sel_hi:[1,0] neg_lo:[0,1] neg_hi:[0,1]
    v_pk_add_f32 v[74:75], v[74:75], v[126:127] op_sel_hi:[1,0] neg_lo:[0,1] neg_hi:[0,1]
    v_mov_b32 v126, v127
    v_pk_mul_f32 v[68:69], v[68:69], v[126:127]
    v_pk_mul_f32 v[70:71], v[70:71], v[126:127]
    v_pk_mul_f32 v[72:73], v[72:73], v[126:127]
    v_pk_mul_f32 v[74:75], v[74:75], v[126:127]
    v_pk_fma_f32 v[76:77], v[68:69], v[20:21], v[76:77]
    v_pk_fma_f32 v[78:79], v[70:71], v[22:23], v[78:79]
    v_pk_fma_f32 v[80:81], v[72:73], v[24:25], v[80:81]
    v_pk_fma_f32 v[82:83], v[74:75], v[26:27], v[82:83]
    v_pk_add_f32 v[76:77], v[76:77], v[28:29]
    v_pk_add_f32 v[78:79], v[78:79], v[30:31]
    v_pk_add_f32 v[80:81], v[80:81], v[32:33]
    v_pk_add_f32 v[82:83], v[82:83], v[34:35]
    s_waitcnt lgkmcnt(0)
    v_pk_add_f32 v[36:37], v[36:37], v[44:45]
    v_pk_add_f32 v[38:39], v[38:39], v[46:47]
    v_pk_add_f32 v[40:41], v[40:41], v[48:49]
    v_pk_add_f32 v[42:43], v[42:43], v[50:51]
    v_pk_add_f32 v[52:53], v[52:53], v[60:61]
    v_pk_add_f32 v[54:55], v[54:55], v[62:63]
    v_pk_add_f32 v[56:57], v[56:57], v[64:65]
    v_pk_add_f32 v[58:59], v[58:59], v[66:67]
    v_pk_add_f32 v[36:37], v[36:37], v[52:53]
    v_pk_add_f32 v[38:39], v[38:39], v[54:55]
    v_pk_add_f32 v[40:41], v[40:41], v[56:57]
    v_pk_add_f32 v[42:43], v[42:43], v[58:59]
    v_pk_add_f32 v[76:77], v[76:77], v[36:37]
    v_pk_add_f32 v[78:79], v[78:79], v[38:39]
    v_pk_add_f32 v[80:81], v[80:81], v[40:41]
    v_pk_add_f32 v[82:83], v[82:83], v[42:43]
    v_cvt_pk_bf16_f32 v92, v76, v77
    v_cvt_pk_bf16_f32 v93, v78, v79
    v_cvt_pk_bf16_f32 v94, v80, v81
    v_cvt_pk_bf16_f32 v95, v82, v83
    buffer_store_dwordx4 v[92:95], v136, s[44:47], s59 offen
    s_endpgm
L_m_end:
L_exit:
    s_endpgm
.p2align 8
.type lag_table,@object
lag_table:
.short 6144,6144,6144,6144,0,256,512,768,1024,1280,1536,1792,8,264,520,776
.short 1032,1288,1544,1800,16,272,528,784,1040,1296,1552,1808,24,280,536,792
.short 1048,1304,1560,1816,32,288,544,800,1056,1312,1568,1824,40,296,552,808
.short 1064,1320,1576,1832,48,304,560,816,1072,1328,1584,1840,56,312,568,824
.short 1080,1336,1592,1848,64,320,576,832,1088,1344,1600,1856,72,328,584,840
.short 1096,1352,1608,1864,80,336,592,848,1104,1360,1616,1872,88,344,600,856
.short 1112,1368,1624,1880,96,352,608,864,1120,1376,1632,1888,104,360,616,872
.short 1128,1384,1640,1896,112,368,624,880,1136,1392,1648,1904,120,376,632,888
.short 1144,1400,1656,1912,128,384,640,896,1152,1408,1664,1920,136,392,648,904
.short 1160,1416,1672,1928,144,400,656,912,1168,1424,1680,1936,152,408,664,920
.short 1176,1432,1688,1944,160,416,672,928,1184,1440,1696,1952,168,424,680,936
.short 1192,1448,1704,1960,176,432,688,944,1200,1456,1712,1968,184,440,696,952
.short 1208,1464,1720,1976,192,448,704,960,1216,1472,1728,1984,200,456,712,968
.short 1224,1480,1736,1992,208,464,720,976,1232,1488,1744,2000,216,472,728,984
.short 1240,1496,1752,2008,224,480,736,992,1248,1504,1760,2016,232,488,744,1000
.short 1256,1512,1768,2024,240,496,752,1008,1264,1520,1776,2032,248,504,760,1016
.short 1272,1528,1784,2040,2048,2048,2304,2560,2560,2560,2816,2056,2056,2056,2312,2568
.short 2568,2568,2824,2064,2064,2064,2320,2576,2576,2576,2832,2072,2072,2072,2328,2584
.short 2584,2584,2840,2080,2080,2080,2336,2592,2592,2592,2848,2088,2088,2088,2344,2600
.short 2600,2600,2856,2096,2096,2096,2352,2608,2608,2608,2864,2104,2104,2104,2360,2616
.short 2616,2616,2872,2112,2112,2112,2368,2624,2624,2624,2880,2120,2120,2120,2376,2632
.short 2632,2632,2888,2128,2128,2128,2384,2640,2640,2640,2896,2136,2136,2136,2392,2648
.short 2648,2648,2904,2144,2144,2144,2400,2656,2656,2656,2912,2152,2152,2152,2408,2664
.short 2664,2664,2920,2160,2160,2160,2416,2672,2672,2672,2928,2168,2168,2168,2424,2680
.short 2680,2680,2936,2176,2176,2176,2432,2688,2688,2688,2944,2184,2184,2184,2440,2696
.short 2696,2696,2952,2192,2192,2192,2448,2704,2704,2704,2960,2200,2200,2200,2456,2712
.short 2712,2712,2968,2208,2208,2208,2464,2720,2720,2720,2976,2216,2216,2216,2472,2728
.short 2728,2728,2984,2224,2224,2224,2480,2736,2736,2736,2992,2232,2232,2232,2488,2744
.short 2744,2744,3000,2240,2240,2240,2496,2752,2752,2752,3008,2248,2248,2248,2504,2760
.short 2760,2760,3016,2256,2256,2256,2512,2768,2768,2768,3024,2264,2264,2264,2520,2776
.short 2776,2776,3032,2272,2272,2272,2528,2784,2784,2784,3040,2280,2280,2280,2536,2792
.short 2792,2792,3048,2288,2288,2288,2544,2800,2800,2800,3056,2296,2296,2296,2552,2808
.short 2808,2808,3064,3072,3072,3072,3072,3328,3328,3328,3080,3080,3080,3080,3080,3336
.short 3336,3336,3088,3088,3088,3088,3088,3344,3344,3344,3096,3096,3096,3096,3096,3352
.short 3352,3352,3104,3104,3104,3104,3104,3360,3360,3360,3112,3112,3112,3112,3112,3368
.short 3368,3368,3120,3120,3120,3120,3120,3376,3376,3376,3128,3128,3128,3128,3128,3384
.short 3384,3384,3136,3136,3136,3136,3136,3392,3392,3392,3144,3144,3144,3144,3144,3400
.short 3400,3400,3152,3152,3152,3152,3152,3408,3408,3408,3160,3160,3160,3160,3160,3416
.short 3416,3416,3168,3168,3168,3168,3168,3424,3424,3424,3176,3176,3176,3176,3176,3432
.short 3432,3432,3184,3184,3184,3184,3184,3440,3440,3440,3192,3192,3192,3192,3192,3448
.short 3448,3448,3200,3200,3200,3200,3200,3456,3456,3456,3208,3208,3208,3208,3208,3464
.short 3464,3464,3216,3216,3216,3216,3216,3472,3472,3472,3224,3224,3224,3224,3224,3480
.short 3480,3480,3232,3232,3232,3232,3232,3488,3488,3488,3240,3240,3240,3240,3240,3496
.short 3496,3496,3248,3248,3248,3248,3248,3504,3504,3504,3256,3256,3256,3256,3256,3512
.short 3512,3512,3264,3264,3264,3264,3264,3520,3520,3520,3272,3272,3272,3272,3272,3528
.short 3528,3528,3280,3280,3280,3280,3280,3536,3536,3536,3288,3288,3288,3288,3288,3544
.short 3544,3544,3296,3296,3296,3296,3296,3552,3552,3552,3304,3304,3304,3304,3304,3560
.short 3560,3560,3312,3312,3312,3312,3312,3568,3568,3568,3320,3320,3320,3320,3320,3576
.short 3576,3576,3584,3584,3584,3584,3584,3840,3840,3840,3592,3592,3592,3592,3592,3848
.short 3848,3848,3600,3600,3600,3600,3600,3856,3856,3856,3608,3608,3608,3608,3608,3864
.short 3864,3864,3616,3616,3616,3616,3616,3872,3872,3872,3624,3624,3624,3624,3624,3880
.short 3880,3880,3632,3632,3632,3632,3632,3888,3888,3888,3640,3640,3640,3640,3640,3896
.short 3896,3896,3648,3648,3648,3648,3648,3904,3904,3904,3656,3656,3656,3656,3656,3912
.short 3912,3912,3664,3664,3664,3664,3664,3920,3920,3920,3672,3672,3672,3672,3672,3928
.short 3928,3928,3680,3680,3680,3680,3680,3936,3936,3936,3688,3688,3688,3688,3688,3944
.short 3944,3944,3696,3696,3696,3696,3696,3952,3952,3952,3704,3704,3704,3704,3704,3960
.short 3960,3960,3712,3712,3712,3712,3712,3968,3968,3968,3720,3720,3720,3720,3720,3976
.short 3976,3976,3728,3728,3728,3728,3728,3984,3984,3984,3736,3736,3736,3736,3736,3992
.short 3992,3992,3744,3744,3744,3744,3744,4000,4000,4000,3752,3752,3752,3752,3752,4008
.short 4008,4008,3760,3760,3760,3760,3760,4016,4016,4016,3768,3768,3768,3768,3768,4024
.short 4024,4024,3776,3776,3776,3776,3776,4032,4032,4032,3784,3784,3784,3784,3784,4040
.short 4040,4040,3792,3792,3792,3792,3792,4048,4048,4048,3800,3800,3800,3800,3800,4056
.short 4056,4056,3808,3808,3808,3808,3808,4064,4064,4064,3816,3816,3816,3816,3816,4072
.short 4072,4072,3824,3824,3824,3824,3824,4080,4080,4080,3832,3832,3832,3832,3832,4088
.short 4088,4088,4096,4096,4096,4096,4096,4096,4096,4104,4104,4104,4104,4104,4104,4104
.short 4112,4112,4112,4112,4112,4112,4112,4112,4112,4120,4120,4120,4120,4120,4120,4120
.short 4128,4128,4128,4128,4128,4128,4128,4128,4128,4136,4136,4136,4136,4136,4136,4136
.short 4144,4144,4144,4144,4144,4144,4144,4144,4144,4152,4152,4152,4152,4152,4152,4152
.short 4160,4160,4160,4160,4160,4160,4160,4160,4160,4168,4168,4168,4168,4168,4168,4168
.short 4176,4176,4176,4176,4176,4176,4176,4176,4176,4184,4184,4184,4184,4184,4184,4184
.short 4192,4192,4192,4192,4192,4192,4192,4192,4192,4200,4200,4200,4200,4200,4200,4200
.short 4208,4208,4208,4208,4208,4208,4208,4208,4208,4216,4216,4216,4216,4216,4216,4216
.short 4224,4224,4224,4224,4224,4224,4224,4224,4224,4232,4232,4232,4232,4232,4232,4232
.short 4240,4240,4240,4240,4240,4240,4240,4240,4240,4248,4248,4248,4248,4248,4248,4248
.short 4256,4256,4256,4256,4256,4256,4256,4256,4256,4264,4264,4264,4264,4264,4264,4264
.short 4272,4272,4272,4272,4272,4272,4272,4272,4272,4280,4280,4280,4280,4280,4280,4280
.short 4288,4288,4288,4288,4288,4288,4288,4288,4288,4296,4296,4296,4296,4296,4296,4296
.short 4304,4304,4304,4304,4304,4304,4304,4304,4304,4312,4312,4312,4312,4312,4312,4312
.short 4320,4320,4320,4320,4320,4320,4320,4320,4320,4328,4328,4328,4328,4328,4328,4328
.short 4336,4336,4336,4336,4336,4336,4336,4336,4336,4344,4344,4344,4344,4344,4344,4344
.short 4352,4352,4352,4352,4352,4352,4352,4352,4352,4360,4360,4360,4360,4360,4360,4360
.short 4368,4368,4368,4368,4368,4368,4368,4368,4368,4376,4376,4376,4376,4376,4376,4376
.short 4384,4384,4384,4384,4384,4384,4384,4384,4384,4392,4392,4392,4392,4392,4392,4392
.short 4400,4400,4400,4400,4400,4400,4400,4400,4400,4408,4408,4408,4408,4408,4408,4408
.short 4416,4416,4416,4416,4416,4416,4416,4416,4416,4424,4424,4424,4424,4424,4424,4424
.short 4432,4432,4432,4432,4432,4432,4432,4432,4432,4440,4440,4440,4440,4440,4440,4440
.short 4448,4448,4448,4448,4448,4448,4448,4448,4448,4456,4456,4456,4456,4456,4456,4456
.short 4464,4464,4464,4464,4464,4464,4464,4464,4464,4472,4472,4472,4472,4472,4472,4472
.short 4480,4480,4480,4480,4480,4480,4480,4480,4480,4488,4488,4488,4488,4488,4488,4488
.short 4496,4496,4496,4496,4496,4496,4496,4496,4496,4504,4504,4504,4504,4504,4504,4504
.short 4512,4512,4512,4512,4512,4512,4512,4512,4512,4520,4520,4520,4520,4520,4520,4520
.short 4528,4528,4528,4528,4528,4528,4528,4528,4528,4536,4536,4536,4536,4536,4536,4536
.short 4544,4544,4544,4544,4544,4544,4544,4544,4544,4552,4552,4552,4552,4552,4552,4552
.short 4560,4560,4560,4560,4560,4560,4560,4560,4560,4568,4568,4568,4568,4568,4568,4568
.short 4576,4576,4576,4576,4576,4576,4576,4576,4576,4584,4584,4584,4584,4584,4584,4584
.short 4592,4592,4592,4592,4592,4592,4592,4592,4592,4600,4600,4600,4600,4600,4600,4600
.short 4608,4608,4608,4608,4608,4608,4608,4608,4608,4616,4616,4616,4616,4616,4616,4616
.short 4624,4624,4624,4624,4624,4624,4624,4624,4624,4632,4632,4632,4632,4632,4632,4632
.short 4640,4640,4640,4640,4640,4640,4640,4640,4640,4648,4648,4648,4648,4648,4648,4648
.short 4656,4656,4656,4656,4656,4656,4656,4656,4656,4664,4664,4664,4664,4664,4664,4664
.short 4672,4672,4672,4672,4672,4672,4672,4672,4672,4680,4680,4680,4680,4680,4680,4680
.short 4688,4688,4688,4688,4688,4688,4688,4688,4688,4696,4696,4696,4696,4696,4696,4696
.short 4704,4704,4704,4704,4704,4704,4704,4704,4704,4712,4712,4712,4712,4712,4712,4712
.short 4720,4720,4720,4720,4720,4720,4720,4720,4720,4728,4728,4728,4728,4728,4728,4728
.short 4736,4736,4736,4736,4736,4736,4736,4736,4736,4744,4744,4744,4744,4744,4744,4744
.short 4752,4752,4752,4752,4752,4752,4752,4752,4752,4760,4760,4760,4760,4760,4760,4760
.short 4768,4768,4768,4768,4768,4768,4768,4768,4768,4776,4776,4776,4776,4776,4776,4776
.short 4784,4784,4784,4784,4784,4784,4784,4784,4784,4792,4792,4792,4792,4792,4792,4792
.short 4800,4800,4800,4800,4800,4800,4800,4800,4800,4808,4808,4808,4808,4808,4808,4808
.short 4816,4816,4816,4816,4816,4816,4816,4816,4816,4824,4824,4824,4824,4824,4824,4824
.short 4832,4832,4832,4832,4832,4832,4832,4832,4832,4840,4840,4840,4840,4840,4840,4840
.short 4848,4848,4848,4848,4848,4848,4848,4848,4848,4856,4856,4856,4856,4856,4856,4856
.short 4864,4864,4864,4864,4864,4864,4864,4864,4864,4872,4872,4872,4872,4872,4872,4872
.short 4880,4880,4880,4880,4880,4880,4880,4880,4880,4888,4888,4888,4888,4888,4888,4888
.short 4896,4896,4896,4896,4896,4896,4896,4896,4896,4904,4904,4904,4904,4904,4904,4904
.short 4912,4912,4912,4912,4912,4912,4912,4912,4912,4920,4920,4920,4920,4920,4920,4920
.short 4928,4928,4928,4928,4928,4928,4928,4928,4928,4936,4936,4936,4936,4936,4936,4936
.short 4944,4944,4944,4944,4944,4944,4944,4944,4944,4952,4952,4952,4952,4952,4952,4952
.short 4960,4960,4960,4960,4960,4960,4960,4960,4960,4968,4968,4968,4968,4968,4968,4968
.short 4976,4976,4976,4976,4976,4976,4976,4976,4976,4984,4984,4984,4984,4984,4984,4984
.short 4992,4992,4992,4992,4992,4992,4992,4992,4992,5000,5000,5000,5000,5000,5000,5000
.short 5008,5008,5008,5008,5008,5008,5008,5008,5008,5016,5016,5016,5016,5016,5016,5016
.short 5024,5024,5024,5024,5024,5024,5024,5024,5024,5032,5032,5032,5032,5032,5032,5032
.short 5040,5040,5040,5040,5040,5040,5040,5040,5040,5048,5048,5048,5048,5048,5048,5048
.short 5056,5056,5056,5056,5056,5056,5056,5056,5056,5064,5064,5064,5064,5064,5064,5064
.short 5072,5072,5072,5072,5072,5072,5072,5072,5072,5080,5080,5080,5080,5080,5080,5080
.short 5088,5088,5088,5088,5088,5088,5088,5088,5088,5096,5096,5096,5096,5096,5096,5096
.short 5104,5104,5104,5104,5104,5104,5104,5104,5104,5112,5112,5112,5112,5112,5112,5112
.short 5120,5120,5120,5120,6144,6144,6144,6144,6144,6144,6144,6144,6144,6144,6144,6144
.size lag_table, .-lag_table
.section .rodata,"a"
.p2align 6
.amdhsa_kernel parallel_sum__ssm_conv_s4__dense_activation_gelu__prompt_kernel
  .amdhsa_next_free_vgpr 256
  .amdhsa_next_free_sgpr 100
  .amdhsa_accum_offset 256
  .amdhsa_group_segment_fixed_size 0
  .amdhsa_kernarg_size 136
  .amdhsa_user_sgpr_count 2
  .amdhsa_user_sgpr_kernarg_segment_ptr 1
  .amdhsa_system_sgpr_workgroup_id_x 1
  .amdhsa_float_denorm_mode_32 3
.end_amdhsa_kernel
```
